```python
import torch

def _softmax(x, axis=-1):
    return torch.softmax(x, dim=axis)
def _gelu(x):
    return torch.nn.functional.gelu(x, approximate="tanh")
def _silu(x):
    return torch.nn.functional.silu(x)
def _sigmoid(x):
    return torch.sigmoid(x)
def _layernorm(x, axis=-1, eps=1e-5):
    m = x.mean(dim=axis, keepdim=True)
    v = x.var(dim=axis, keepdim=True, unbiased=False)
    return (x - m) / torch.sqrt(v + eps)
def _scatter_add(tgt, idx, src, axis=0):
    return tgt.clone().index_add_(axis, idx, src)
def _segment_sum(src, seg, n):
    out = torch.zeros((n,) + src.shape[1:], dtype=src.dtype)
    return out.index_add_(0, seg, src)
def _pad(x, pw):
    flat = tuple(v for pair in reversed(pw) for v in pair)
    return torch.nn.functional.pad(x, flat)

kernel_name = 'concat_heads__mha_block_cached__sliding_block_cached__decode'

def setup_inputs():

    _w = (lambda a: (lambda t: t.to(torch.bfloat16) if t.is_floating_point() else t)(torch.as_tensor(a)))
    def _A_setup():
        B, Sq, D = 2, 1, 640
        H, Sk, Dh = 32, 4096, 192
        return {
            "x": _w((lambda *s: torch.randn(*s, dtype=torch.bfloat16) * 0.4)(B, Sq, D)),
            "k_cache": _w((lambda *s: torch.randn(*s, dtype=torch.bfloat16) * 3.2)(B, H, Sk, Dh)),
            "v_cache": _w((lambda *s: torch.randn(*s, dtype=torch.bfloat16) * 0.8)(B, H, Sk, Dh)),
            "wq": _w((lambda *s: torch.randn(*s, dtype=torch.bfloat16) * 3.2)(D, H * Dh) * (D ** -0.5)),
            "wo": _w((lambda *s: torch.randn(*s, dtype=torch.bfloat16) * 0.8)(H * Dh, D) * ((H * Dh) ** -0.5)),
        }
    _A_in = _A_setup()

    def _B_setup():
        B, Sq, D = 2, 1, 640
        Hq, Hkv, Sk, Dh = 32, 32, 4096, 192
        assert Hq % Hkv == 0, (Hq, Hkv)
        return {
            "x": _w((lambda *s: torch.randn(*s, dtype=torch.bfloat16) * 0.2)(B, Sq, D)),
            "k_cache": _w((lambda *s: torch.randn(*s, dtype=torch.bfloat16) * 3.2)(B, Hkv, Sk, Dh)),
            "v_cache": _w((lambda *s: torch.randn(*s, dtype=torch.bfloat16) * 1.6)(B, Hkv, Sk, Dh)),
            "wq": _w((lambda *s: torch.randn(*s, dtype=torch.bfloat16) * 3.2)(D, Hq * Dh) * (D ** -0.5)),
            "wo": _w((lambda *s: torch.randn(*s, dtype=torch.bfloat16) * 1.6)(Hq * Dh, D) * ((Hq * Dh) ** -0.5)),
        }
    _B_in = _B_setup()

    return {
        "A_x": _A_in["x"],
        "A_k_cache": _A_in["k_cache"],
        "A_v_cache": _A_in["v_cache"],
        "A_wq": _A_in["wq"],
        "A_wo": _A_in["wo"],
        "B_x": _B_in["x"],
        "B_k_cache": _B_in["k_cache"],
        "B_v_cache": _B_in["v_cache"],
        "B_wq": _B_in["wq"],
        "B_wo": _B_in["wo"],
    }

def reference(A_x, A_k_cache, A_v_cache, A_wq, A_wo, B_x, B_k_cache, B_v_cache, B_wq, B_wo):
    def _A_ref(x, k_cache, v_cache, wq, wo):
        B, Sq, D = x.shape
        H, Dh = 32, 192
        q = (lambda x, *d: x.permute(*d))((x @ wq).reshape(B, Sq, H, Dh), 0, 2, 1, 3)
        scores = torch.einsum("bhqd,bhkd->bhqk", q, k_cache) * (Dh ** -0.5)
        p = _softmax(scores, axis=-1)
        o = torch.einsum("bhqk,bhkd->bhqd", p, v_cache)
        return (lambda x, *d: x.permute(*d))(o, 0, 2, 1, 3).reshape(B, Sq, H * Dh) @ wo

    def _B_ref(x, k_cache, v_cache, wq, wo):
        B, Sq, D = x.shape
        Hq, Dh = 32, 192
        Hkv, Sk = k_cache.shape[1], k_cache.shape[2]
        W = min(4096, max(256, Sk // 4))
        rep = Hq // Hkv
        q = (lambda x, *d: x.permute(*d))((x @ wq).reshape(B, Sq, Hq, Dh), 0, 2, 1, 3)
        k = (lambda x, n, axis: torch.repeat_interleave(x, n, dim=axis))(k_cache[:, :, Sk - W:, :], rep, axis=1)
        v = (lambda x, n, axis: torch.repeat_interleave(x, n, dim=axis))(v_cache[:, :, Sk - W:, :], rep, axis=1)
        scores = torch.einsum("bhqd,bhkd->bhqk", q, k) * (Dh ** -0.5)
        p = _softmax(scores, axis=-1)
        o = torch.einsum("bhqk,bhkd->bhqd", p, v)
        return (lambda x, *d: x.permute(*d))(o, 0, 2, 1, 3).reshape(B, Sq, Hq * Dh) @ wo

    a = _A_ref(A_x, A_k_cache, A_v_cache, A_wq, A_wo)
    b = _B_ref(B_x, B_k_cache, B_v_cache, B_wq, B_wo)
    return torch.concatenate([a, b], axis=-1)
```

```asm
; @launch grid=(256,1,1) block=(1024,1,1) lds=47168
.amdgcn_target "amdgcn-amd-amdhsa--gfx950"
.text
.globl concat_heads__mha_block_cached__sliding_block_cached__decode_kernel
.p2align 8
.type concat_heads__mha_block_cached__sliding_block_cached__decode_kernel,@function
concat_heads__mha_block_cached__sliding_block_cached__decode_kernel:
  s_cmp_ge_u32 s2, 256
  s_cbranch_scc1 L_done
  s_load_dwordx16 s[16:31], s[0:1], 0
  s_load_dwordx8 s[32:39], s[0:1], 64
  s_load_dwordx2 s[40:41], s[0:1], 96
  s_and_b32 s11, s2, 7
  s_lshr_b32 s12, s2, 3
  s_lshl_b32 s11, s11, 2
  s_lshr_b32 s13, s12, 3
  s_add_u32 s3, s11, s13
  s_and_b32 s4, s12, 7
  s_lshr_b32 s5, s4, 2
  s_and_b32 s6, s4, 3
  v_and_b32 v1, 63, v0
  v_lshrrev_b32 v4, 6, v0
  s_nop 0
  v_readfirstlane_b32 s10, v4
  s_lshl_b32 s11, s5, 5
  s_add_u32 s11, s11, s3
  s_mul_i32 s11, s11, 1572864
  s_mul_i32 s12, s6, 390144
  s_add_u32 s7, s11, s12
  s_mul_i32 s12, s6, 98304
  s_add_u32 s8, s11, s12
  s_add_u32 s8, s8, 1179648
  v_lshrrev_b32 v5, 3, v1
  v_and_b32 v6, 7, v1
  v_lshlrev_b32 v3, 4, v6
  v_mul_u32_u24 v2, 384, v5
  v_add_u32 v2, v2, v3
  v_mul_u32_u24 v7, 3072, v4
  v_add_u32 v2, v2, v7
  v_mov_b32 v8, 47104
  v_mov_b32 v9, 0
  ds_write_b32 v8, v9
  v_mul_u32_u24 v62, 40, v4
  v_add_u32 v62, v62, v5
  v_mul_u32_u24 v60, 12288, v62
  v_add_u32 v60, v60, v3
  v_mul_u32_u24 v63, 160, v4
  v_min_u32 v7, 39, v1
  v_lshl_add_u32 v62, v7, 2, v63
  v_lshl_add_u32 v63, v5, 1, v63
  v_cmp_le_u32 vcc, 20, v7
  v_mul_u32_u24 v61, 80, v4
  v_lshl_add_u32 v61, v7, 2, v61
  v_cndmask_b32 v7, 0, 1, vcc
  v_mul_u32_u24 v7, 1200, v7
  v_add_u32 v61, v61, v7
  s_mov_b32 s14, s5
  s_mov_b32 s15, s6
  s_cmp_eq_u32 s6, 3
  s_movk_i32 s12, 127
  s_cselect_b32 s12, 131, s12
  s_add_u32 s13, s10, 112
  s_add_u32 s87, s7, 344064
  s_cmp_lt_u32 s13, s12
  s_cselect_b32 s87, s87, 0x7f000000
  s_cselect_b32 s89, 0, 0xf149f2ca
  s_add_u32 s13, s10, 128
  s_add_u32 s88, s7, 393216
  s_cmp_lt_u32 s13, s12
  s_cselect_b32 s88, s88, 0x7f000000
  s_cselect_b32 s90, 0, 0xf149f2ca
  s_waitcnt lgkmcnt(0)
  s_load_dword s9, s[40:41], 0
  s_mov_b32 s44, s18
  s_and_b32 s45, s19, 0xffff
  s_mov_b32 s46, 100663296
  s_mov_b32 s47, 0x00020000
  s_cmp_eq_u32 s14, 0
  s_cselect_b32 s60, s22, s32
  s_cselect_b32 s61, s23, s33
  s_cselect_b32 s64, s16, s26
  s_cselect_b32 s65, s17, s27
  s_and_b32 s61, s61, 0xffff
  s_mov_b32 s62, 7864320
  s_mov_b32 s63, 0x00020000
  s_and_b32 s65, s65, 0xffff
  s_mov_b32 s66, 2560
  s_mov_b32 s67, 0x00020000
  s_cmp_ge_u32 s6, 3
  s_cbranch_scc1 L_noq1
  s_mul_i32 s11, s3, 384
  s_lshl_b32 s12, s15, 7
  s_add_u32 s11, s11, s12
  buffer_load_dword v87, v61, s[64:67], 0 offen
  buffer_load_dwordx4 v[64:67], v60, s[60:63], s11 offen nt
  s_add_u32 s11, s11, 98304
  buffer_load_dwordx4 v[68:71], v60, s[60:63], s11 offen nt
  s_add_u32 s11, s11, 98304
  buffer_load_dwordx4 v[72:75], v60, s[60:63], s11 offen nt
  s_add_u32 s11, s11, 98304
  buffer_load_dwordx4 v[76:79], v60, s[60:63], s11 offen nt
  s_add_u32 s11, s11, 98304
  buffer_load_dwordx4 v[80:83], v60, s[60:63], s11 offen nt
  s_waitcnt vmcnt(5)
  ds_write_b32 v62, v87 offset:9216
  ds_read_u16 v84, v63 offset:9216
  ds_read_u16 v85, v63 offset:9296
  ds_read_u16 v88, v63 offset:9232
  ds_read_u16 v89, v63 offset:9312
  ds_read_u16 v92, v63 offset:9248
  ds_read_u16 v93, v63 offset:9328
  ds_read_u16 v96, v63 offset:9264
  ds_read_u16 v97, v63 offset:9344
  ds_read_u16 v100, v63 offset:9280
  ds_read_u16 v101, v63 offset:9360
  s_waitcnt vmcnt(2)
L_noq1:
  s_add_u32 s84, s7, 0
  buffer_load_dwordx4 v[104:107], v2, s[44:47], s84 offen offset:0 nt
  buffer_load_dwordx4 v[108:111], v2, s[44:47], s84 offen offset:128 nt
  buffer_load_dwordx4 v[112:115], v2, s[44:47], s84 offen offset:256 nt
  s_add_u32 s84, s7, 49152
  buffer_load_dwordx4 v[116:119], v2, s[44:47], s84 offen offset:0 nt
  s_mov_b32 s48, s20
  s_and_b32 s49, s21, 0xffff
  s_mov_b32 s50, 100663296
  s_mov_b32 s51, 0x00020000
  s_mov_b32 s52, s28
  s_and_b32 s53, s29, 0xffff
  s_mov_b32 s54, 100663296
  s_mov_b32 s55, 0x00020000
  s_mov_b32 s56, s30
  s_and_b32 s57, s31, 0xffff
  s_mov_b32 s58, 100663296
  s_mov_b32 s59, 0x00020000
  s_mov_b32 s72, s40
  s_and_b32 s73, s41, 0xffff
  s_mov_b32 s74, 434115584
  s_mov_b32 s75, 0x00020000
  s_mov_b32 s76, s36
  s_and_b32 s77, s37, 0xffff
  s_mov_b32 s78, 5120
  s_mov_b32 s79, 0x00020000
  s_cmp_lt_u32 s4, 4
  s_cselect_b32 s68, s24, s34
  s_cselect_b32 s69, s25, s35
  s_and_b32 s69, s69, 0xffff
  s_mov_b32 s70, 7864320
  s_mov_b32 s71, 0x00020000
  s_waitcnt lgkmcnt(0)
  s_mul_i32 s9, s9, 0x9E3779B1
  s_add_u32 s9, s9, 0x7F4A7C15
  s_lshl_b32 s11, s3, 1
  s_lshr_b32 s12, s10, 2
  s_add_u32 s11, s11, s12
  s_lshl_b32 s11, s11, 3
  s_add_u32 s11, s11, s4
  s_lshl_b32 s11, s11, 11
  s_add_u32 s11, s11, 131072
  s_lshl_b32 s12, s3, 1
  s_add_u32 s12, s12, s5
  s_mul_i32 s12, s12, 5
  s_add_u32 s12, s12, s6
  s_lshl_b32 s12, s12, 11
  s_add_u32 s42, s12, 1179648
  s_cmp_lt_u32 s10, 8
  s_cselect_b32 s11, s11, s42
  s_movk_i32 s12, 511
  s_cselect_b32 s12, 255, s12
  v_and_b32 v122, s12, v0
  v_min_u32 v122, 319, v122
  v_lshlrev_b32 v122, 3, v122
  v_mov_b32 v120, 0
  s_not_b32 s13, s9
  v_mov_b32 v121, s13
  s_nop 0
  s_cmp_ge_u32 s6, 3
  s_cbranch_scc1 L_noq2b
  s_waitcnt vmcnt(4) lgkmcnt(0)
  v_lshlrev_b32 v86, 16, v84
  v_lshlrev_b32 v87, 16, v85
  v_lshlrev_b32 v90, 16, v88
  v_lshlrev_b32 v91, 16, v89
  v_lshlrev_b32 v94, 16, v92
  v_lshlrev_b32 v95, 16, v93
  v_lshlrev_b32 v98, 16, v96
  v_lshlrev_b32 v99, 16, v97
  v_lshlrev_b32 v102, 16, v100
  v_lshlrev_b32 v103, 16, v101
  v_dot2_f32_bf16 v36, v64, v84, 0
  v_dot2_f32_bf16 v37, v64, v86, 0
  v_dot2_f32_bf16 v38, v65, v84, 0
  v_dot2_f32_bf16 v39, v65, v86, 0
  v_dot2_f32_bf16 v40, v66, v84, 0
  v_dot2_f32_bf16 v41, v66, v86, 0
  v_dot2_f32_bf16 v42, v67, v84, 0
  v_dot2_f32_bf16 v43, v67, v86, 0
  v_dot2_f32_bf16 v44, v64, v85, 0
  v_dot2_f32_bf16 v45, v64, v87, 0
  v_dot2_f32_bf16 v46, v65, v85, 0
  v_dot2_f32_bf16 v47, v65, v87, 0
  v_dot2_f32_bf16 v48, v66, v85, 0
  v_dot2_f32_bf16 v49, v66, v87, 0
  v_dot2_f32_bf16 v50, v67, v85, 0
  v_dot2_f32_bf16 v51, v67, v87, 0
  v_dot2_f32_bf16 v36, v68, v88, v36
  v_dot2_f32_bf16 v37, v68, v90, v37
  v_dot2_f32_bf16 v38, v69, v88, v38
  v_dot2_f32_bf16 v39, v69, v90, v39
  v_dot2_f32_bf16 v40, v70, v88, v40
  v_dot2_f32_bf16 v41, v70, v90, v41
  v_dot2_f32_bf16 v42, v71, v88, v42
  v_dot2_f32_bf16 v43, v71, v90, v43
  v_dot2_f32_bf16 v44, v68, v89, v44
  v_dot2_f32_bf16 v45, v68, v91, v45
  v_dot2_f32_bf16 v46, v69, v89, v46
  v_dot2_f32_bf16 v47, v69, v91, v47
  v_dot2_f32_bf16 v48, v70, v89, v48
  v_dot2_f32_bf16 v49, v70, v91, v49
  v_dot2_f32_bf16 v50, v71, v89, v50
  v_dot2_f32_bf16 v51, v71, v91, v51
  v_dot2_f32_bf16 v36, v72, v92, v36
  v_dot2_f32_bf16 v37, v72, v94, v37
  v_dot2_f32_bf16 v38, v73, v92, v38
  v_dot2_f32_bf16 v39, v73, v94, v39
  v_dot2_f32_bf16 v40, v74, v92, v40
  v_dot2_f32_bf16 v41, v74, v94, v41
  v_dot2_f32_bf16 v42, v75, v92, v42
  v_dot2_f32_bf16 v43, v75, v94, v43
  v_dot2_f32_bf16 v44, v72, v93, v44
  v_dot2_f32_bf16 v45, v72, v95, v45
  v_dot2_f32_bf16 v46, v73, v93, v46
  v_dot2_f32_bf16 v47, v73, v95, v47
  v_dot2_f32_bf16 v48, v74, v93, v48
  v_dot2_f32_bf16 v49, v74, v95, v49
  v_dot2_f32_bf16 v50, v75, v93, v50
  v_dot2_f32_bf16 v51, v75, v95, v51
  v_dot2_f32_bf16 v36, v76, v96, v36
  v_dot2_f32_bf16 v37, v76, v98, v37
  v_dot2_f32_bf16 v38, v77, v96, v38
  v_dot2_f32_bf16 v39, v77, v98, v39
  v_dot2_f32_bf16 v40, v78, v96, v40
  v_dot2_f32_bf16 v41, v78, v98, v41
  v_dot2_f32_bf16 v42, v79, v96, v42
  v_dot2_f32_bf16 v43, v79, v98, v43
  v_dot2_f32_bf16 v44, v76, v97, v44
  v_dot2_f32_bf16 v45, v76, v99, v45
  v_dot2_f32_bf16 v46, v77, v97, v46
  v_dot2_f32_bf16 v47, v77, v99, v47
  v_dot2_f32_bf16 v48, v78, v97, v48
  v_dot2_f32_bf16 v49, v78, v99, v49
  v_dot2_f32_bf16 v50, v79, v97, v50
  v_dot2_f32_bf16 v51, v79, v99, v51
  v_dot2_f32_bf16 v36, v80, v100, v36
  v_dot2_f32_bf16 v37, v80, v102, v37
  v_dot2_f32_bf16 v38, v81, v100, v38
  v_dot2_f32_bf16 v39, v81, v102, v39
  v_dot2_f32_bf16 v40, v82, v100, v40
  v_dot2_f32_bf16 v41, v82, v102, v41
  v_dot2_f32_bf16 v42, v83, v100, v42
  v_dot2_f32_bf16 v43, v83, v102, v43
  v_dot2_f32_bf16 v44, v80, v101, v44
  v_dot2_f32_bf16 v45, v80, v103, v45
  v_dot2_f32_bf16 v46, v81, v101, v46
  v_dot2_f32_bf16 v47, v81, v103, v47
  v_dot2_f32_bf16 v48, v82, v101, v48
  v_dot2_f32_bf16 v49, v82, v103, v49
  v_dot2_f32_bf16 v50, v83, v101, v50
  v_dot2_f32_bf16 v51, v83, v103, v51
  v_permlane32_swap_b32 v36, v44
  v_permlane32_swap_b32 v37, v45
  v_permlane32_swap_b32 v38, v46
  v_permlane32_swap_b32 v39, v47
  v_permlane32_swap_b32 v40, v48
  v_permlane32_swap_b32 v41, v49
  v_permlane32_swap_b32 v42, v50
  v_permlane32_swap_b32 v43, v51
  v_add_f32 v36, v36, v44
  v_add_f32 v37, v37, v45
  v_add_f32 v38, v38, v46
  v_add_f32 v39, v39, v47
  v_add_f32 v40, v40, v48
  v_add_f32 v41, v41, v49
  v_add_f32 v42, v42, v50
  v_add_f32 v43, v43, v51
  v_permlane16_swap_b32 v36, v40
  v_permlane16_swap_b32 v37, v41
  v_permlane16_swap_b32 v38, v42
  v_permlane16_swap_b32 v39, v43
  v_add_f32 v36, v36, v40
  v_add_f32 v37, v37, v41
  v_add_f32 v38, v38, v42
  v_add_f32 v39, v39, v43
  v_add_f32_dpp v36, v36, v36 row_ror:8 row_mask:0xf bank_mask:0xf
  v_add_f32_dpp v37, v37, v37 row_ror:8 row_mask:0xf bank_mask:0xf
  v_add_f32_dpp v38, v38, v38 row_ror:8 row_mask:0xf bank_mask:0xf
  v_add_f32_dpp v39, v39, v39 row_ror:8 row_mask:0xf bank_mask:0xf
  v_lshrrev_b32 v4, 5, v1
  v_lshlrev_b32 v4, 8, v4
  v_lshl_add_u32 v4, v3, 1, v4
  v_and_b32 v5, 16, v1
  v_add_u32 v4, v4, v5
  s_lshl_b32 s11, s10, 9
  v_add_u32 v4, s11, v4
  ds_write_b128 v4, v[36:39] offset:0
  s_waitcnt lgkmcnt(0)
  s_barrier
  s_cmp_lg_u32 s10, 0
  s_cbranch_scc1 L_noq2
  v_lshlrev_b32 v4, 3, v1
  ds_read_b64 v[36:37], v4 offset:0
  ds_read_b64 v[38:39], v4 offset:512
  ds_read_b64 v[40:41], v4 offset:1024
  ds_read_b64 v[42:43], v4 offset:1536
  ds_read_b64 v[44:45], v4 offset:2048
  ds_read_b64 v[46:47], v4 offset:2560
  ds_read_b64 v[48:49], v4 offset:3072
  ds_read_b64 v[50:51], v4 offset:3584
  ds_read_b64 v[52:53], v4 offset:4096
  ds_read_b64 v[54:55], v4 offset:4608
  ds_read_b64 v[56:57], v4 offset:5120
  ds_read_b64 v[58:59], v4 offset:5632
  ds_read_b64 v[60:61], v4 offset:6144
  ds_read_b64 v[62:63], v4 offset:6656
  ds_read_b64 v[64:65], v4 offset:7168
  ds_read_b64 v[66:67], v4 offset:7680
  v_lshrrev_b32 v5, 5, v1
  v_mul_u32_u24 v5, 1536, v5
  v_and_b32 v6, 31, v1
  v_lshl_add_u32 v5, v6, 3, v5
  s_mul_i32 s11, s3, 3072
  s_mul_i32 s12, s14, 768
  s_add_u32 s11, s11, s12
  s_lshl_b32 s12, s15, 8
  s_add_u32 s11, s11, s12
  s_add_u32 s11, s11, 4096
  s_waitcnt lgkmcnt(0)
  v_add_f32 v36, v36, v38
  v_add_f32 v37, v37, v39
  v_add_f32 v40, v40, v42
  v_add_f32 v41, v41, v43
  v_add_f32 v44, v44, v46
  v_add_f32 v45, v45, v47
  v_add_f32 v48, v48, v50
  v_add_f32 v49, v49, v51
  v_add_f32 v52, v52, v54
  v_add_f32 v53, v53, v55
  v_add_f32 v56, v56, v58
  v_add_f32 v57, v57, v59
  v_add_f32 v60, v60, v62
  v_add_f32 v61, v61, v63
  v_add_f32 v64, v64, v66
  v_add_f32 v65, v65, v67
  v_add_f32 v36, v36, v40
  v_add_f32 v37, v37, v41
  v_add_f32 v44, v44, v48
  v_add_f32 v45, v45, v49
  v_add_f32 v52, v52, v56
  v_add_f32 v53, v53, v57
  v_add_f32 v60, v60, v64
  v_add_f32 v61, v61, v65
  v_add_f32 v36, v36, v44
  v_add_f32 v37, v37, v45
  v_add_f32 v52, v52, v60
  v_add_f32 v53, v53, v61
  v_add_f32 v36, v36, v52
  v_add_f32 v37, v37, v53
  v_cvt_pk_bf16_f32 v6, v36, v37
  v_mov_b32 v7, s9
  buffer_store_dwordx2 v[6:7], v5, s[72:75], s11 offen sc1
  s_branch L_noq2
L_noq2b:
  s_waitcnt lgkmcnt(0)
  s_barrier
L_noq2:
  s_nop 7
  s_nop 3
  s_cmp_eq_u32 s10, 1
  s_cbranch_scc1 L_poll
  v_mov_b32 v4, 47104
  s_waitcnt vmcnt(3)
  ds_read_b32 v5, v4
  s_waitcnt lgkmcnt(0)
  v_cmp_eq_u32 vcc, 1, v5
  s_cbranch_vccnz L_burst0
  buffer_load_dwordx4 v[36:39], v2, s[44:47], s84 offen offset:128 nt
  s_waitcnt vmcnt(3)
  ds_read_b32 v5, v4
  s_waitcnt lgkmcnt(0)
  v_cmp_eq_u32 vcc, 1, v5
  s_cbranch_vccnz L_burst1
  buffer_load_dwordx4 v[40:43], v2, s[44:47], s84 offen offset:256 nt
  s_waitcnt vmcnt(3)
  ds_read_b32 v5, v4
  s_waitcnt lgkmcnt(0)
  v_cmp_eq_u32 vcc, 1, v5
  s_cbranch_vccnz L_burst2
  s_add_u32 s84, s7, 98304
  buffer_load_dwordx4 v[44:47], v2, s[44:47], s84 offen offset:0 nt
  s_waitcnt vmcnt(3)
  ds_read_b32 v5, v4
  s_waitcnt lgkmcnt(0)
  v_cmp_eq_u32 vcc, 1, v5
  s_cbranch_vccnz L_burst3
  buffer_load_dwordx4 v[48:51], v2, s[44:47], s84 offen offset:128 nt
  s_waitcnt vmcnt(3)
  ds_read_b32 v5, v4
  s_waitcnt lgkmcnt(0)
  v_cmp_eq_u32 vcc, 1, v5
  s_cbranch_vccnz L_burst4
  buffer_load_dwordx4 v[52:55], v2, s[44:47], s84 offen offset:256 nt
  s_waitcnt vmcnt(3)
  ds_read_b32 v5, v4
  s_waitcnt lgkmcnt(0)
  v_cmp_eq_u32 vcc, 1, v5
  s_cbranch_vccnz L_burst5
  s_add_u32 s84, s7, 147456
  buffer_load_dwordx4 v[56:59], v2, s[44:47], s84 offen offset:0 nt
  s_waitcnt vmcnt(3)
  ds_read_b32 v5, v4
  s_waitcnt lgkmcnt(0)
  v_cmp_eq_u32 vcc, 1, v5
  s_cbranch_vccnz L_burst6
  buffer_load_dwordx4 v[60:63], v2, s[44:47], s84 offen offset:128 nt
  s_waitcnt vmcnt(3)
  ds_read_b32 v5, v4
  s_waitcnt lgkmcnt(0)
  v_cmp_eq_u32 vcc, 1, v5
  s_cbranch_vccnz L_burst7
  buffer_load_dwordx4 v[64:67], v2, s[44:47], s84 offen offset:256 nt
  s_waitcnt vmcnt(3)
  ds_read_b32 v5, v4
  s_waitcnt lgkmcnt(0)
  v_cmp_eq_u32 vcc, 1, v5
  s_cbranch_vccnz L_burst8
  s_add_u32 s84, s7, 196608
  buffer_load_dwordx4 v[68:71], v2, s[44:47], s84 offen offset:0 nt
  s_waitcnt vmcnt(3)
  ds_read_b32 v5, v4
  s_waitcnt lgkmcnt(0)
  v_cmp_eq_u32 vcc, 1, v5
  s_cbranch_vccnz L_burst9
  buffer_load_dwordx4 v[72:75], v2, s[44:47], s84 offen offset:128 nt
  s_waitcnt vmcnt(3)
  ds_read_b32 v5, v4
  s_waitcnt lgkmcnt(0)
  v_cmp_eq_u32 vcc, 1, v5
  s_cbranch_vccnz L_burst10
  buffer_load_dwordx4 v[76:79], v2, s[44:47], s84 offen offset:256 nt
  s_waitcnt vmcnt(3)
  ds_read_b32 v5, v4
  s_waitcnt lgkmcnt(0)
  v_cmp_eq_u32 vcc, 1, v5
  s_cbranch_vccnz L_burst11
  s_add_u32 s84, s7, 245760
  buffer_load_dwordx4 v[80:83], v2, s[44:47], s84 offen offset:0 nt
  s_waitcnt vmcnt(3)
  ds_read_b32 v5, v4
  s_waitcnt lgkmcnt(0)
  v_cmp_eq_u32 vcc, 1, v5
  s_cbranch_vccnz L_burst12
  buffer_load_dwordx4 v[84:87], v2, s[44:47], s84 offen offset:128 nt
  s_waitcnt vmcnt(3)
  ds_read_b32 v5, v4
  s_waitcnt lgkmcnt(0)
  v_cmp_eq_u32 vcc, 1, v5
  s_cbranch_vccnz L_burst13
  buffer_load_dwordx4 v[88:91], v2, s[44:47], s84 offen offset:256 nt
  s_waitcnt vmcnt(3)
  ds_read_b32 v5, v4
  s_waitcnt lgkmcnt(0)
  v_cmp_eq_u32 vcc, 1, v5
  s_cbranch_vccnz L_burst14
  s_add_u32 s84, s7, 294912
  buffer_load_dwordx4 v[92:95], v2, s[44:47], s84 offen offset:0 nt
  s_waitcnt vmcnt(3)
  ds_read_b32 v5, v4
  s_waitcnt lgkmcnt(0)
  v_cmp_eq_u32 vcc, 1, v5
  s_cbranch_vccnz L_burst15
  buffer_load_dwordx4 v[96:99], v2, s[44:47], s84 offen offset:128 nt
  s_waitcnt vmcnt(3)
  ds_read_b32 v5, v4
  s_waitcnt lgkmcnt(0)
  v_cmp_eq_u32 vcc, 1, v5
  s_cbranch_vccnz L_burst16
  buffer_load_dwordx4 v[100:103], v2, s[44:47], s84 offen offset:256 nt
  s_waitcnt vmcnt(3)
  ds_read_b32 v5, v4
  s_waitcnt lgkmcnt(0)
  v_cmp_eq_u32 vcc, 1, v5
  s_cbranch_vccnz L_burst17
  buffer_load_dwordx4 v[120:123], v2, s[44:47], s87 offen offset:0 nt
  s_waitcnt vmcnt(3)
  ds_read_b32 v5, v4
  s_waitcnt lgkmcnt(0)
  v_cmp_eq_u32 vcc, 1, v5
  s_cbranch_vccnz L_burst18
  buffer_load_dwordx4 v[124:127], v2, s[44:47], s87 offen offset:128 nt
  s_mov_b32 s12, 0
L_qspin:
  ds_read_b32 v5, v4
  s_add_u32 s12, s12, 1
  s_waitcnt lgkmcnt(0)
  v_cmp_eq_u32 vcc, 1, v5
  s_cbranch_vccnz L_qready
  s_sleep 2
  s_cmp_lt_u32 s12, 4194304
  s_cbranch_scc1 L_qspin
  s_branch L_qready
L_poll:
  s_nop 7
  s_nop 3
  s_setprio 3
  s_lshl_b32 s11, s3, 1
  s_add_u32 s11, s11, s5
  s_mul_i32 s11, s11, 1536
  s_add_u32 s11, s11, 4096
  v_lshlrev_b32 v124, 4, v1
  v_and_b32 v125, 31, v1
  v_lshlrev_b32 v125, 4, v125
  v_add_u32 v125, 1024, v125
  s_mov_b32 s12, 0
  buffer_load_dwordx4 v[92:95], v124, s[72:75], s11 offen sc1
  buffer_load_dwordx4 v[96:99], v125, s[72:75], s11 offen sc1
  s_sleep 12
L_poll_loop:
  s_nop 7
  s_nop 3
  buffer_load_dwordx4 v[100:103], v124, s[72:75], s11 offen sc1
  buffer_load_dwordx4 v[120:123], v125, s[72:75], s11 offen sc1
  s_waitcnt vmcnt(2)
  v_xor_b32 v126, s9, v93
  v_xor_b32 v127, s9, v95
  v_xor_b32 v93, s9, v97
  v_xor_b32 v95, s9, v99
  v_or_b32 v126, v126, v127
  v_or3_b32 v126, v126, v93, v95
  v_cmp_ne_u32 vcc, 0, v126
  s_cmp_eq_u64 vcc, 0
  s_cbranch_scc1 L_poll_done0
  buffer_load_dwordx4 v[92:95], v124, s[72:75], s11 offen sc1
  buffer_load_dwordx4 v[96:99], v125, s[72:75], s11 offen sc1
  s_waitcnt vmcnt(2)
  v_xor_b32 v126, s9, v101
  v_xor_b32 v127, s9, v103
  v_xor_b32 v101, s9, v121
  v_xor_b32 v103, s9, v123
  v_or_b32 v126, v126, v127
  v_or3_b32 v126, v126, v101, v103
  v_cmp_ne_u32 vcc, 0, v126
  s_cmp_eq_u64 vcc, 0
  s_cbranch_scc1 L_poll_done1
  s_add_u32 s12, s12, 1
  s_cmp_lt_u32 s12, 262144
  s_cbranch_scc1 L_poll_loop
L_poll_done1:
  s_nop 7
  s_nop 3
  v_lshrrev_b32 v124, 1, v124
  v_lshrrev_b32 v125, 1, v125
  v_add_u32 v124, 8192, v124
  v_add_u32 v125, 8192, v125
  ds_write2_b32 v124, v100, v102 offset0:0 offset1:1
  ds_write2_b32 v125, v120, v122 offset0:0 offset1:1
  s_branch L_poll_fin
L_poll_done0:
  s_nop 7
  s_nop 3
  v_lshrrev_b32 v124, 1, v124
  v_lshrrev_b32 v125, 1, v125
  v_add_u32 v124, 8192, v124
  v_add_u32 v125, 8192, v125
  ds_write2_b32 v124, v92, v94 offset0:0 offset1:1
  ds_write2_b32 v125, v96, v98 offset0:0 offset1:1
L_poll_fin:
  v_mov_b32 v126, 47104
  v_mov_b32 v127, 1
  s_waitcnt lgkmcnt(0)
  ds_write_b32 v126, v127
  s_setprio 0
L_burst0:
  buffer_load_dwordx4 v[36:39], v2, s[44:47], s84 offen offset:128 nt
L_burst1:
  buffer_load_dwordx4 v[40:43], v2, s[44:47], s84 offen offset:256 nt
L_burst2:
  s_add_u32 s84, s7, 98304
  buffer_load_dwordx4 v[44:47], v2, s[44:47], s84 offen offset:0 nt
L_burst3:
  buffer_load_dwordx4 v[48:51], v2, s[44:47], s84 offen offset:128 nt
L_burst4:
  buffer_load_dwordx4 v[52:55], v2, s[44:47], s84 offen offset:256 nt
L_burst5:
  s_add_u32 s84, s7, 147456
  buffer_load_dwordx4 v[56:59], v2, s[44:47], s84 offen offset:0 nt
L_burst6:
  buffer_load_dwordx4 v[60:63], v2, s[44:47], s84 offen offset:128 nt
L_burst7:
  buffer_load_dwordx4 v[64:67], v2, s[44:47], s84 offen offset:256 nt
L_burst8:
  s_add_u32 s84, s7, 196608
  buffer_load_dwordx4 v[68:71], v2, s[44:47], s84 offen offset:0 nt
L_burst9:
  buffer_load_dwordx4 v[72:75], v2, s[44:47], s84 offen offset:128 nt
L_burst10:
  buffer_load_dwordx4 v[76:79], v2, s[44:47], s84 offen offset:256 nt
L_burst11:
  s_add_u32 s84, s7, 245760
  buffer_load_dwordx4 v[80:83], v2, s[44:47], s84 offen offset:0 nt
L_burst12:
  buffer_load_dwordx4 v[84:87], v2, s[44:47], s84 offen offset:128 nt
L_burst13:
  buffer_load_dwordx4 v[88:91], v2, s[44:47], s84 offen offset:256 nt
L_burst14:
  s_add_u32 s84, s7, 294912
  buffer_load_dwordx4 v[92:95], v2, s[44:47], s84 offen offset:0 nt
L_burst15:
  buffer_load_dwordx4 v[96:99], v2, s[44:47], s84 offen offset:128 nt
L_burst16:
  buffer_load_dwordx4 v[100:103], v2, s[44:47], s84 offen offset:256 nt
L_burst17:
  buffer_load_dwordx4 v[120:123], v2, s[44:47], s87 offen offset:0 nt
L_burst18:
  buffer_load_dwordx4 v[124:127], v2, s[44:47], s87 offen offset:128 nt
L_qready:
  s_nop 7
  s_nop 3
  ds_read_b128 v[24:27], v3 offset:8192
  ds_read_b128 v[28:31], v3 offset:8320
  ds_read_b128 v[32:35], v3 offset:8448
  s_waitcnt lgkmcnt(0)
  s_waitcnt vmcnt(22)
  v_dot2_f32_bf16 v8, v104, v24, 0
  v_dot2_f32_bf16 v8, v105, v25, v8
  v_dot2_f32_bf16 v8, v106, v26, v8
  v_dot2_f32_bf16 v8, v107, v27, v8
  buffer_load_dwordx4 v[104:107], v2, s[44:47], s87 offen offset:256 nt
  s_waitcnt vmcnt(22)
  v_dot2_f32_bf16 v8, v108, v28, v8
  v_dot2_f32_bf16 v8, v109, v29, v8
  v_dot2_f32_bf16 v8, v110, v30, v8
  v_dot2_f32_bf16 v8, v111, v31, v8
  buffer_load_dwordx4 v[108:111], v2, s[44:47], s88 offen offset:0 nt
  s_waitcnt vmcnt(22)
  v_dot2_f32_bf16 v8, v112, v32, v8
  v_dot2_f32_bf16 v8, v113, v33, v8
  v_dot2_f32_bf16 v8, v114, v34, v8
  v_dot2_f32_bf16 v8, v115, v35, v8
  buffer_load_dwordx4 v[112:115], v2, s[44:47], s88 offen offset:128 nt
  s_waitcnt vmcnt(22)
  v_dot2_f32_bf16 v9, v116, v24, 0
  v_dot2_f32_bf16 v9, v117, v25, v9
  v_dot2_f32_bf16 v9, v118, v26, v9
  v_dot2_f32_bf16 v9, v119, v27, v9
  buffer_load_dwordx4 v[116:119], v2, s[44:47], s88 offen offset:256 nt
  s_waitcnt vmcnt(22)
  v_dot2_f32_bf16 v9, v36, v28, v9
  v_dot2_f32_bf16 v9, v37, v29, v9
  v_dot2_f32_bf16 v9, v38, v30, v9
  v_dot2_f32_bf16 v9, v39, v31, v9
  s_add_u32 s84, s8, 0
  buffer_load_dwordx4 v[36:39], v2, s[52:55], s84 offen offset:0 nt
  s_waitcnt vmcnt(22)
  v_dot2_f32_bf16 v9, v40, v32, v9
  v_dot2_f32_bf16 v9, v41, v33, v9
  v_dot2_f32_bf16 v9, v42, v34, v9
  v_dot2_f32_bf16 v9, v43, v35, v9
  buffer_load_dwordx4 v[40:43], v2, s[52:55], s84 offen offset:128 nt
  s_waitcnt vmcnt(22)
  v_dot2_f32_bf16 v10, v44, v24, 0
  v_dot2_f32_bf16 v10, v45, v25, v10
  v_dot2_f32_bf16 v10, v46, v26, v10
  v_dot2_f32_bf16 v10, v47, v27, v10
  buffer_load_dwordx4 v[44:47], v2, s[52:55], s84 offen offset:256 nt
  s_waitcnt vmcnt(22)
  v_dot2_f32_bf16 v10, v48, v28, v10
  v_dot2_f32_bf16 v10, v49, v29, v10
  v_dot2_f32_bf16 v10, v50, v30, v10
  v_dot2_f32_bf16 v10, v51, v31, v10
  s_add_u32 s84, s8, 49152
  buffer_load_dwordx4 v[48:51], v2, s[52:55], s84 offen offset:0 nt
  s_waitcnt vmcnt(22)
  v_dot2_f32_bf16 v10, v52, v32, v10
  v_dot2_f32_bf16 v10, v53, v33, v10
  v_dot2_f32_bf16 v10, v54, v34, v10
  v_dot2_f32_bf16 v10, v55, v35, v10
  buffer_load_dwordx4 v[52:55], v2, s[52:55], s84 offen offset:128 nt
  s_waitcnt vmcnt(22)
  v_dot2_f32_bf16 v11, v56, v24, 0
  v_dot2_f32_bf16 v11, v57, v25, v11
  v_dot2_f32_bf16 v11, v58, v26, v11
  v_dot2_f32_bf16 v11, v59, v27, v11
  buffer_load_dwordx4 v[56:59], v2, s[52:55], s84 offen offset:256 nt
  s_waitcnt vmcnt(22)
  v_dot2_f32_bf16 v11, v60, v28, v11
  v_dot2_f32_bf16 v11, v61, v29, v11
  v_dot2_f32_bf16 v11, v62, v30, v11
  v_dot2_f32_bf16 v11, v63, v31, v11
  s_add_u32 s84, s7, 0
  buffer_load_dwordx4 v[60:63], v2, s[48:51], s84 offen offset:0 nt
  s_waitcnt vmcnt(22)
  v_dot2_f32_bf16 v11, v64, v32, v11
  v_dot2_f32_bf16 v11, v65, v33, v11
  v_dot2_f32_bf16 v11, v66, v34, v11
  v_dot2_f32_bf16 v11, v67, v35, v11
  buffer_load_dwordx4 v[64:67], v2, s[48:51], s84 offen offset:128 nt
  s_waitcnt vmcnt(22)
  v_dot2_f32_bf16 v12, v68, v24, 0
  v_dot2_f32_bf16 v12, v69, v25, v12
  v_dot2_f32_bf16 v12, v70, v26, v12
  v_dot2_f32_bf16 v12, v71, v27, v12
  buffer_load_dwordx4 v[68:71], v2, s[48:51], s84 offen offset:256 nt
  s_waitcnt vmcnt(22)
  v_dot2_f32_bf16 v12, v72, v28, v12
  v_dot2_f32_bf16 v12, v73, v29, v12
  v_dot2_f32_bf16 v12, v74, v30, v12
  v_dot2_f32_bf16 v12, v75, v31, v12
  s_add_u32 s84, s7, 49152
  buffer_load_dwordx4 v[72:75], v2, s[48:51], s84 offen offset:0 nt
  s_waitcnt vmcnt(22)
  v_dot2_f32_bf16 v12, v76, v32, v12
  v_dot2_f32_bf16 v12, v77, v33, v12
  v_dot2_f32_bf16 v12, v78, v34, v12
  v_dot2_f32_bf16 v12, v79, v35, v12
  buffer_load_dwordx4 v[76:79], v2, s[48:51], s84 offen offset:128 nt
  s_waitcnt vmcnt(22)
  v_dot2_f32_bf16 v13, v80, v24, 0
  v_dot2_f32_bf16 v13, v81, v25, v13
  v_dot2_f32_bf16 v13, v82, v26, v13
  v_dot2_f32_bf16 v13, v83, v27, v13
  buffer_load_dwordx4 v[80:83], v2, s[48:51], s84 offen offset:256 nt
  s_waitcnt vmcnt(22)
  v_dot2_f32_bf16 v13, v84, v28, v13
  v_dot2_f32_bf16 v13, v85, v29, v13
  v_dot2_f32_bf16 v13, v86, v30, v13
  v_dot2_f32_bf16 v13, v87, v31, v13
  s_add_u32 s84, s7, 98304
  buffer_load_dwordx4 v[84:87], v2, s[48:51], s84 offen offset:0 nt
  s_waitcnt vmcnt(22)
  v_dot2_f32_bf16 v13, v88, v32, v13
  v_dot2_f32_bf16 v13, v89, v33, v13
  v_dot2_f32_bf16 v13, v90, v34, v13
  v_dot2_f32_bf16 v13, v91, v35, v13
  buffer_load_dwordx4 v[88:91], v2, s[48:51], s84 offen offset:128 nt
  s_waitcnt vmcnt(22)
  v_dot2_f32_bf16 v14, v92, v24, 0
  v_dot2_f32_bf16 v14, v93, v25, v14
  v_dot2_f32_bf16 v14, v94, v26, v14
  v_dot2_f32_bf16 v14, v95, v27, v14
  buffer_load_dwordx4 v[92:95], v2, s[48:51], s84 offen offset:256 nt
  s_waitcnt vmcnt(22)
  v_dot2_f32_bf16 v14, v96, v28, v14
  v_dot2_f32_bf16 v14, v97, v29, v14
  v_dot2_f32_bf16 v14, v98, v30, v14
  v_dot2_f32_bf16 v14, v99, v31, v14
  s_add_u32 s84, s7, 147456
  buffer_load_dwordx4 v[96:99], v2, s[48:51], s84 offen offset:0 nt
  s_waitcnt vmcnt(22)
  v_dot2_f32_bf16 v14, v100, v32, v14
  v_dot2_f32_bf16 v14, v101, v33, v14
  v_dot2_f32_bf16 v14, v102, v34, v14
  v_dot2_f32_bf16 v14, v103, v35, v14
  buffer_load_dwordx4 v[100:103], v2, s[48:51], s84 offen offset:128 nt
  s_waitcnt vmcnt(22)
  v_dot2_f32_bf16 v15, v120, v24, 0
  v_dot2_f32_bf16 v15, v121, v25, v15
  v_dot2_f32_bf16 v15, v122, v26, v15
  v_dot2_f32_bf16 v15, v123, v27, v15
  buffer_load_dwordx4 v[120:123], v2, s[48:51], s84 offen offset:256 nt
  s_waitcnt vmcnt(22)
  v_dot2_f32_bf16 v15, v124, v28, v15
  v_dot2_f32_bf16 v15, v125, v29, v15
  v_dot2_f32_bf16 v15, v126, v30, v15
  v_dot2_f32_bf16 v15, v127, v31, v15
  s_add_u32 s84, s7, 196608
  buffer_load_dwordx4 v[124:127], v2, s[48:51], s84 offen offset:0 nt
  s_waitcnt vmcnt(22)
  v_dot2_f32_bf16 v15, v104, v32, v15
  v_dot2_f32_bf16 v15, v105, v33, v15
  v_dot2_f32_bf16 v15, v106, v34, v15
  v_dot2_f32_bf16 v15, v107, v35, v15
  buffer_load_dwordx4 v[104:107], v2, s[48:51], s84 offen offset:128 nt
  s_waitcnt vmcnt(22)
  v_dot2_f32_bf16 v16, v108, v24, 0
  v_dot2_f32_bf16 v16, v109, v25, v16
  v_dot2_f32_bf16 v16, v110, v26, v16
  v_dot2_f32_bf16 v16, v111, v27, v16
  buffer_load_dwordx4 v[108:111], v2, s[48:51], s84 offen offset:256 nt
  s_waitcnt vmcnt(22)
  v_dot2_f32_bf16 v16, v112, v28, v16
  v_dot2_f32_bf16 v16, v113, v29, v16
  v_dot2_f32_bf16 v16, v114, v30, v16
  v_dot2_f32_bf16 v16, v115, v31, v16
  s_add_u32 s84, s7, 245760
  buffer_load_dwordx4 v[112:115], v2, s[48:51], s84 offen offset:0 nt
  s_waitcnt vmcnt(22)
  v_dot2_f32_bf16 v16, v116, v32, v16
  v_dot2_f32_bf16 v16, v117, v33, v16
  v_dot2_f32_bf16 v16, v118, v34, v16
  v_dot2_f32_bf16 v16, v119, v35, v16
  buffer_load_dwordx4 v[116:119], v2, s[48:51], s84 offen offset:128 nt
  ds_read_b128 v[24:27], v3 offset:8576
  ds_read_b128 v[28:31], v3 offset:8704
  ds_read_b128 v[32:35], v3 offset:8832
  s_waitcnt lgkmcnt(0)
  s_waitcnt vmcnt(22)
  v_dot2_f32_bf16 v17, v36, v24, 0
  v_dot2_f32_bf16 v17, v37, v25, v17
  v_dot2_f32_bf16 v17, v38, v26, v17
  v_dot2_f32_bf16 v17, v39, v27, v17
  s_waitcnt vmcnt(21)
  v_dot2_f32_bf16 v17, v40, v28, v17
  v_dot2_f32_bf16 v17, v41, v29, v17
  v_dot2_f32_bf16 v17, v42, v30, v17
  v_dot2_f32_bf16 v17, v43, v31, v17
  s_waitcnt vmcnt(20)
  v_dot2_f32_bf16 v17, v44, v32, v17
  v_dot2_f32_bf16 v17, v45, v33, v17
  v_dot2_f32_bf16 v17, v46, v34, v17
  v_dot2_f32_bf16 v17, v47, v35, v17
  s_waitcnt vmcnt(19)
  v_dot2_f32_bf16 v18, v48, v24, 0
  v_dot2_f32_bf16 v18, v49, v25, v18
  v_dot2_f32_bf16 v18, v50, v26, v18
  v_dot2_f32_bf16 v18, v51, v27, v18
  s_waitcnt vmcnt(18)
  v_dot2_f32_bf16 v18, v52, v28, v18
  v_dot2_f32_bf16 v18, v53, v29, v18
  v_dot2_f32_bf16 v18, v54, v30, v18
  v_dot2_f32_bf16 v18, v55, v31, v18
  s_waitcnt vmcnt(17)
  v_dot2_f32_bf16 v18, v56, v32, v18
  v_dot2_f32_bf16 v18, v57, v33, v18
  v_dot2_f32_bf16 v18, v58, v34, v18
  v_dot2_f32_bf16 v18, v59, v35, v18
  buffer_load_dwordx4 v[24:27], v2, s[48:51], s84 offen offset:256 nt
  s_add_u32 s84, s7, 294912
  buffer_load_dwordx4 v[28:31], v2, s[48:51], s84 offen offset:0 nt
  buffer_load_dwordx4 v[32:35], v2, s[48:51], s84 offen offset:128 nt
  v_add_f32_dpp v8, v8, v8 quad_perm:[1,0,3,2] row_mask:0xf bank_mask:0xf
  v_add_f32_dpp v9, v9, v9 quad_perm:[1,0,3,2] row_mask:0xf bank_mask:0xf
  v_add_f32_dpp v10, v10, v10 quad_perm:[1,0,3,2] row_mask:0xf bank_mask:0xf
  v_add_f32_dpp v11, v11, v11 quad_perm:[1,0,3,2] row_mask:0xf bank_mask:0xf
  v_add_f32_dpp v12, v12, v12 quad_perm:[1,0,3,2] row_mask:0xf bank_mask:0xf
  v_add_f32_dpp v13, v13, v13 quad_perm:[1,0,3,2] row_mask:0xf bank_mask:0xf
  v_add_f32_dpp v14, v14, v14 quad_perm:[1,0,3,2] row_mask:0xf bank_mask:0xf
  v_add_f32_dpp v15, v15, v15 quad_perm:[1,0,3,2] row_mask:0xf bank_mask:0xf
  v_add_f32_dpp v16, v16, v16 quad_perm:[1,0,3,2] row_mask:0xf bank_mask:0xf
  v_add_f32_dpp v17, v17, v17 quad_perm:[1,0,3,2] row_mask:0xf bank_mask:0xf
  v_add_f32_dpp v18, v18, v18 quad_perm:[1,0,3,2] row_mask:0xf bank_mask:0xf
  v_add_f32_dpp v8, v8, v8 quad_perm:[2,3,0,1] row_mask:0xf bank_mask:0xf
  v_add_f32_dpp v9, v9, v9 quad_perm:[2,3,0,1] row_mask:0xf bank_mask:0xf
  v_add_f32_dpp v10, v10, v10 quad_perm:[2,3,0,1] row_mask:0xf bank_mask:0xf
  v_add_f32_dpp v11, v11, v11 quad_perm:[2,3,0,1] row_mask:0xf bank_mask:0xf
  v_add_f32_dpp v12, v12, v12 quad_perm:[2,3,0,1] row_mask:0xf bank_mask:0xf
  v_add_f32_dpp v13, v13, v13 quad_perm:[2,3,0,1] row_mask:0xf bank_mask:0xf
  v_add_f32_dpp v14, v14, v14 quad_perm:[2,3,0,1] row_mask:0xf bank_mask:0xf
  v_add_f32_dpp v15, v15, v15 quad_perm:[2,3,0,1] row_mask:0xf bank_mask:0xf
  v_add_f32_dpp v16, v16, v16 quad_perm:[2,3,0,1] row_mask:0xf bank_mask:0xf
  v_add_f32_dpp v17, v17, v17 quad_perm:[2,3,0,1] row_mask:0xf bank_mask:0xf
  v_add_f32_dpp v18, v18, v18 quad_perm:[2,3,0,1] row_mask:0xf bank_mask:0xf
  v_add_f32_dpp v8, v8, v8 row_half_mirror row_mask:0xf bank_mask:0xf
  v_add_f32_dpp v9, v9, v9 row_half_mirror row_mask:0xf bank_mask:0xf
  v_add_f32_dpp v10, v10, v10 row_half_mirror row_mask:0xf bank_mask:0xf
  v_add_f32_dpp v11, v11, v11 row_half_mirror row_mask:0xf bank_mask:0xf
  v_add_f32_dpp v12, v12, v12 row_half_mirror row_mask:0xf bank_mask:0xf
  v_add_f32_dpp v13, v13, v13 row_half_mirror row_mask:0xf bank_mask:0xf
  v_add_f32_dpp v14, v14, v14 row_half_mirror row_mask:0xf bank_mask:0xf
  v_add_f32_dpp v15, v15, v15 row_half_mirror row_mask:0xf bank_mask:0xf
  v_add_f32_dpp v16, v16, v16 row_half_mirror row_mask:0xf bank_mask:0xf
  v_add_f32_dpp v17, v17, v17 row_half_mirror row_mask:0xf bank_mask:0xf
  v_add_f32_dpp v18, v18, v18 row_half_mirror row_mask:0xf bank_mask:0xf
  s_mov_b32 s11, 0x3D93CD3A
  s_mov_b32 s12, 0xffff0000
  s_mov_b32 s13, 0x3FB8AA3B
  v_cvt_pk_bf16_f32 v9, v8, v9
  v_cvt_pk_bf16_f32 v11, v10, v11
  v_cvt_pk_bf16_f32 v13, v12, v13
  v_cvt_pk_bf16_f32 v15, v14, v15
  v_cvt_pk_bf16_f32 v17, v16, v17
  v_cvt_pk_bf16_f32 v18, v18, v18
  v_lshlrev_b32 v8, 16, v9
  v_and_b32 v9, s12, v9
  v_lshlrev_b32 v10, 16, v11
  v_and_b32 v11, s12, v11
  v_lshlrev_b32 v12, 16, v13
  v_and_b32 v13, s12, v13
  v_lshlrev_b32 v14, 16, v15
  v_and_b32 v15, s12, v15
  v_lshlrev_b32 v16, 16, v17
  v_and_b32 v17, s12, v17
  v_and_b32 v18, s12, v18
  v_mul_f32 v8, s11, v8
  v_mul_f32 v9, s11, v9
  v_mul_f32 v10, s11, v10
  v_mul_f32 v11, s11, v11
  v_mul_f32 v12, s11, v12
  v_mul_f32 v13, s11, v13
  v_mul_f32 v14, s11, v14
  v_mul_f32 v15, s11, v15
  v_mul_f32 v16, s11, v16
  v_mul_f32 v17, s11, v17
  v_mul_f32 v18, s11, v18
  v_cvt_pk_bf16_f32 v9, v8, v9
  v_cvt_pk_bf16_f32 v11, v10, v11
  v_cvt_pk_bf16_f32 v13, v12, v13
  v_cvt_pk_bf16_f32 v15, v14, v15
  v_cvt_pk_bf16_f32 v17, v16, v17
  v_cvt_pk_bf16_f32 v18, v18, v18
  v_lshlrev_b32 v8, 16, v9
  v_and_b32 v9, s12, v9
  v_lshlrev_b32 v10, 16, v11
  v_and_b32 v11, s12, v11
  v_lshlrev_b32 v12, 16, v13
  v_and_b32 v13, s12, v13
  v_lshlrev_b32 v14, 16, v15
  v_and_b32 v15, s12, v15
  v_lshlrev_b32 v16, 16, v17
  v_and_b32 v17, s12, v17
  v_and_b32 v18, s12, v18
  v_add_f32 v15, s89, v15
  v_add_f32 v16, s90, v16
  v_max_f32 v22, v17, v18
  v_max3_f32 v19, v8, v9, v10
  v_max3_f32 v4, v13, v14, v15
  v_max3_f32 v19, v19, v11, v12
  v_max_f32 v4, v4, v16
  v_max_f32 v19, v19, v4
  s_nop 1
  v_max_f32_dpp v19, v19, v19 row_ror:8 row_mask:0xf bank_mask:0xf
  v_max_f32_dpp v22, v22, v22 row_ror:8 row_mask:0xf bank_mask:0xf
  v_mov_b32 v4, v19
  v_mov_b32 v5, v22
  s_nop 0
  v_permlane16_swap_b32 v19, v4
  v_permlane16_swap_b32 v22, v5
  v_max_f32 v19, v19, v4
  v_max_f32 v22, v22, v5
  v_mov_b32 v4, v19
  v_mov_b32 v5, v22
  s_nop 0
  v_permlane32_swap_b32 v19, v4
  v_permlane32_swap_b32 v22, v5
  v_max_f32 v19, v19, v4
  v_max_f32 v22, v22, v5
  v_sub_f32 v8, v8, v19
  v_sub_f32 v9, v9, v19
  v_sub_f32 v10, v10, v19
  v_sub_f32 v11, v11, v19
  v_sub_f32 v12, v12, v19
  v_sub_f32 v13, v13, v19
  v_sub_f32 v14, v14, v19
  v_sub_f32 v15, v15, v19
  v_sub_f32 v16, v16, v19
  v_sub_f32 v17, v17, v22
  v_sub_f32 v18, v18, v22
  v_mul_f32 v8, s13, v8
  v_mul_f32 v9, s13, v9
  v_mul_f32 v10, s13, v10
  v_mul_f32 v11, s13, v11
  v_mul_f32 v12, s13, v12
  v_mul_f32 v13, s13, v13
  v_mul_f32 v14, s13, v14
  v_mul_f32 v15, s13, v15
  v_mul_f32 v16, s13, v16
  v_mul_f32 v17, s13, v17
  v_mul_f32 v18, s13, v18
  v_exp_f32 v8, v8
  v_exp_f32 v9, v9
  v_exp_f32 v10, v10
  v_exp_f32 v11, v11
  v_exp_f32 v12, v12
  v_exp_f32 v13, v13
  v_exp_f32 v14, v14
  v_exp_f32 v15, v15
  v_exp_f32 v16, v16
  v_exp_f32 v17, v17
  v_exp_f32 v18, v18
  s_nop 0
  v_add_f32 v21, v17, v18
  v_add_f32 v20, v8, v9
  v_add_f32 v4, v13, v14
  v_add_f32 v20, v20, v10
  v_add_f32 v4, v4, v15
  v_add_f32 v20, v20, v11
  v_add_f32 v4, v4, v16
  v_add_f32 v20, v20, v12
  v_add_f32 v20, v20, v4
  s_nop 1
  v_add_f32_dpp v20, v20, v20 row_ror:8 row_mask:0xf bank_mask:0xf
  v_add_f32_dpp v21, v21, v21 row_ror:8 row_mask:0xf bank_mask:0xf
  v_mov_b32 v4, v20
  v_mov_b32 v5, v21
  s_nop 0
  v_permlane16_swap_b32 v20, v4
  v_permlane16_swap_b32 v21, v5
  v_add_f32 v20, v20, v4
  v_add_f32 v21, v21, v5
  v_mov_b32 v4, v20
  v_mov_b32 v5, v21
  s_nop 0
  v_permlane32_swap_b32 v20, v4
  v_permlane32_swap_b32 v21, v5
  v_add_f32 v20, v20, v4
  v_add_f32 v21, v21, v5
  s_lshl_b32 s11, s10, 3
  v_mov_b32 v4, s11
  v_mov_b32 v6, v19
  v_mov_b32 v7, v20
  ds_write_b64 v4, v[6:7] offset:33792
  v_mov_b32 v20, v22
  ds_write_b64 v4, v[20:21] offset:33920
  v_lshrrev_b32 v4, 4, v1
  v_mul_u32_u24 v4, 10240, v4
  v_and_b32 v5, 15, v1
  v_lshl_add_u32 v19, v5, 4, v4
  s_cmp_ge_u32 s10, 6
  s_cselect_b32 s92, 1, 0
  s_mul_i32 s11, s92, 6
  s_sub_u32 s93, s10, s11
  s_mul_i32 s11, s93, 40960
  s_add_u32 s12, s92, s6
  s_lshl_b32 s12, s12, 8
  s_add_u32 s11, s11, s12
  s_mul_i32 s12, s3, 245760
  s_add_u32 s85, s11, s12
  s_cmp_eq_u32 s6, 3
  s_cselect_b32 s91, 12, 6
  s_cmp_ge_u32 s10, s91
  s_cselect_b32 s85, 0x7f000000, s85
  s_add_u32 s86, s85, 5120
  v_lshrrev_b32 v4, 5, v1
  v_lshlrev_b32 v4, 4, v4
  v_lshl_add_u32 v4, v3, 1, v4
  v_bfe_u32 v5, v1, 4, 1
  v_lshl_add_u32 v4, v5, 3, v4
  s_mul_i32 s11, s10, 768
  v_add_u32 v22, s11, v4
  v_cvt_pk_bf16_f32 v4, v8, 0
  v_cvt_pk_bf16_f32 v5, 0, v8
  s_waitcnt vmcnt(19)
  v_dot2_f32_bf16 v36, v60, v4, 0
  v_dot2_f32_bf16 v37, v60, v5, 0
  v_dot2_f32_bf16 v38, v61, v4, 0
  v_dot2_f32_bf16 v39, v61, v5, 0
  v_dot2_f32_bf16 v40, v62, v4, 0
  v_dot2_f32_bf16 v41, v62, v5, 0
  v_dot2_f32_bf16 v42, v63, v4, 0
  v_dot2_f32_bf16 v43, v63, v5, 0
  buffer_load_dwordx4 v[60:63], v2, s[48:51], s84 offen offset:256 nt
  s_waitcnt vmcnt(19)
  v_dot2_f32_bf16 v44, v64, v4, 0
  v_dot2_f32_bf16 v45, v64, v5, 0
  v_dot2_f32_bf16 v46, v65, v4, 0
  v_dot2_f32_bf16 v47, v65, v5, 0
  v_dot2_f32_bf16 v48, v66, v4, 0
  v_dot2_f32_bf16 v49, v66, v5, 0
  v_dot2_f32_bf16 v50, v67, v4, 0
  v_dot2_f32_bf16 v51, v67, v5, 0
  buffer_load_dwordx4 v[64:67], v2, s[48:51], s87 offen offset:0 nt
  s_waitcnt vmcnt(19)
  v_dot2_f32_bf16 v52, v68, v4, 0
  v_dot2_f32_bf16 v53, v68, v5, 0
  v_dot2_f32_bf16 v54, v69, v4, 0
  v_dot2_f32_bf16 v55, v69, v5, 0
  v_dot2_f32_bf16 v56, v70, v4, 0
  v_dot2_f32_bf16 v57, v70, v5, 0
  v_dot2_f32_bf16 v58, v71, v4, 0
  v_dot2_f32_bf16 v59, v71, v5, 0
  buffer_load_dwordx4 v[68:71], v2, s[48:51], s87 offen offset:128 nt
  v_cvt_pk_bf16_f32 v4, v9, 0
  v_cvt_pk_bf16_f32 v5, 0, v9
  s_waitcnt vmcnt(19)
  v_dot2_f32_bf16 v36, v72, v4, v36
  v_dot2_f32_bf16 v37, v72, v5, v37
  v_dot2_f32_bf16 v38, v73, v4, v38
  v_dot2_f32_bf16 v39, v73, v5, v39
  v_dot2_f32_bf16 v40, v74, v4, v40
  v_dot2_f32_bf16 v41, v74, v5, v41
  v_dot2_f32_bf16 v42, v75, v4, v42
  v_dot2_f32_bf16 v43, v75, v5, v43
  buffer_load_dwordx4 v[72:75], v2, s[48:51], s87 offen offset:256 nt
  s_waitcnt vmcnt(19)
  v_dot2_f32_bf16 v44, v76, v4, v44
  v_dot2_f32_bf16 v45, v76, v5, v45
  v_dot2_f32_bf16 v46, v77, v4, v46
  v_dot2_f32_bf16 v47, v77, v5, v47
  v_dot2_f32_bf16 v48, v78, v4, v48
  v_dot2_f32_bf16 v49, v78, v5, v49
  v_dot2_f32_bf16 v50, v79, v4, v50
  v_dot2_f32_bf16 v51, v79, v5, v51
  buffer_load_dwordx4 v[76:79], v2, s[48:51], s88 offen offset:0 nt
  s_waitcnt vmcnt(19)
  v_dot2_f32_bf16 v52, v80, v4, v52
  v_dot2_f32_bf16 v53, v80, v5, v53
  v_dot2_f32_bf16 v54, v81, v4, v54
  v_dot2_f32_bf16 v55, v81, v5, v55
  v_dot2_f32_bf16 v56, v82, v4, v56
  v_dot2_f32_bf16 v57, v82, v5, v57
  v_dot2_f32_bf16 v58, v83, v4, v58
  v_dot2_f32_bf16 v59, v83, v5, v59
  buffer_load_dwordx4 v[80:83], v2, s[48:51], s88 offen offset:128 nt
  v_cvt_pk_bf16_f32 v4, v10, 0
  v_cvt_pk_bf16_f32 v5, 0, v10
  s_waitcnt vmcnt(19)
  v_dot2_f32_bf16 v36, v84, v4, v36
  v_dot2_f32_bf16 v37, v84, v5, v37
  v_dot2_f32_bf16 v38, v85, v4, v38
  v_dot2_f32_bf16 v39, v85, v5, v39
  v_dot2_f32_bf16 v40, v86, v4, v40
  v_dot2_f32_bf16 v41, v86, v5, v41
  v_dot2_f32_bf16 v42, v87, v4, v42
  v_dot2_f32_bf16 v43, v87, v5, v43
  buffer_load_dwordx4 v[84:87], v2, s[48:51], s88 offen offset:256 nt
  s_waitcnt vmcnt(19)
  v_dot2_f32_bf16 v44, v88, v4, v44
  v_dot2_f32_bf16 v45, v88, v5, v45
  v_dot2_f32_bf16 v46, v89, v4, v46
  v_dot2_f32_bf16 v47, v89, v5, v47
  v_dot2_f32_bf16 v48, v90, v4, v48
  v_dot2_f32_bf16 v49, v90, v5, v49
  v_dot2_f32_bf16 v50, v91, v4, v50
  v_dot2_f32_bf16 v51, v91, v5, v51
  s_add_u32 s84, s8, 0
  buffer_load_dwordx4 v[88:91], v2, s[56:59], s84 offen offset:0 nt
  s_waitcnt vmcnt(19)
  v_dot2_f32_bf16 v52, v92, v4, v52
  v_dot2_f32_bf16 v53, v92, v5, v53
  v_dot2_f32_bf16 v54, v93, v4, v54
  v_dot2_f32_bf16 v55, v93, v5, v55
  v_dot2_f32_bf16 v56, v94, v4, v56
  v_dot2_f32_bf16 v57, v94, v5, v57
  v_dot2_f32_bf16 v58, v95, v4, v58
  v_dot2_f32_bf16 v59, v95, v5, v59
  buffer_load_dwordx4 v[92:95], v2, s[56:59], s84 offen offset:128 nt
  v_cvt_pk_bf16_f32 v4, v11, 0
  v_cvt_pk_bf16_f32 v5, 0, v11
  s_waitcnt vmcnt(19)
  v_dot2_f32_bf16 v36, v96, v4, v36
  v_dot2_f32_bf16 v37, v96, v5, v37
  v_dot2_f32_bf16 v38, v97, v4, v38
  v_dot2_f32_bf16 v39, v97, v5, v39
  v_dot2_f32_bf16 v40, v98, v4, v40
  v_dot2_f32_bf16 v41, v98, v5, v41
  v_dot2_f32_bf16 v42, v99, v4, v42
  v_dot2_f32_bf16 v43, v99, v5, v43
  buffer_load_dwordx4 v[96:99], v2, s[56:59], s84 offen offset:256 nt
  s_waitcnt vmcnt(19)
  v_dot2_f32_bf16 v44, v100, v4, v44
  v_dot2_f32_bf16 v45, v100, v5, v45
  v_dot2_f32_bf16 v46, v101, v4, v46
  v_dot2_f32_bf16 v47, v101, v5, v47
  v_dot2_f32_bf16 v48, v102, v4, v48
  v_dot2_f32_bf16 v49, v102, v5, v49
  v_dot2_f32_bf16 v50, v103, v4, v50
  v_dot2_f32_bf16 v51, v103, v5, v51
  s_add_u32 s84, s8, 49152
  buffer_load_dwordx4 v[100:103], v2, s[56:59], s84 offen offset:0 nt
  s_waitcnt vmcnt(19)
  v_dot2_f32_bf16 v52, v120, v4, v52
  v_dot2_f32_bf16 v53, v120, v5, v53
  v_dot2_f32_bf16 v54, v121, v4, v54
  v_dot2_f32_bf16 v55, v121, v5, v55
  v_dot2_f32_bf16 v56, v122, v4, v56
  v_dot2_f32_bf16 v57, v122, v5, v57
  v_dot2_f32_bf16 v58, v123, v4, v58
  v_dot2_f32_bf16 v59, v123, v5, v59
  buffer_load_dwordx4 v[120:123], v2, s[56:59], s84 offen offset:128 nt
  v_cvt_pk_bf16_f32 v4, v12, 0
  v_cvt_pk_bf16_f32 v5, 0, v12
  s_waitcnt vmcnt(19)
  v_dot2_f32_bf16 v36, v124, v4, v36
  v_dot2_f32_bf16 v37, v124, v5, v37
  v_dot2_f32_bf16 v38, v125, v4, v38
  v_dot2_f32_bf16 v39, v125, v5, v39
  v_dot2_f32_bf16 v40, v126, v4, v40
  v_dot2_f32_bf16 v41, v126, v5, v41
  v_dot2_f32_bf16 v42, v127, v4, v42
  v_dot2_f32_bf16 v43, v127, v5, v43
  buffer_load_dwordx4 v[124:127], v2, s[56:59], s84 offen offset:256 nt
  s_waitcnt vmcnt(19)
  v_dot2_f32_bf16 v44, v104, v4, v44
  v_dot2_f32_bf16 v45, v104, v5, v45
  v_dot2_f32_bf16 v46, v105, v4, v46
  v_dot2_f32_bf16 v47, v105, v5, v47
  v_dot2_f32_bf16 v48, v106, v4, v48
  v_dot2_f32_bf16 v49, v106, v5, v49
  v_dot2_f32_bf16 v50, v107, v4, v50
  v_dot2_f32_bf16 v51, v107, v5, v51
  buffer_load_dwordx4 v[104:107], v19, s[68:71], s85 offen offset:0 nt
  s_waitcnt vmcnt(19)
  v_dot2_f32_bf16 v52, v108, v4, v52
  v_dot2_f32_bf16 v53, v108, v5, v53
  v_dot2_f32_bf16 v54, v109, v4, v54
  v_dot2_f32_bf16 v55, v109, v5, v55
  v_dot2_f32_bf16 v56, v110, v4, v56
  v_dot2_f32_bf16 v57, v110, v5, v57
  v_dot2_f32_bf16 v58, v111, v4, v58
  v_dot2_f32_bf16 v59, v111, v5, v59
  buffer_load_dwordx4 v[108:111], v19, s[68:71], s85 offen offset:1280 nt
  v_cvt_pk_bf16_f32 v4, v13, 0
  v_cvt_pk_bf16_f32 v5, 0, v13
  s_waitcnt vmcnt(19)
  v_dot2_f32_bf16 v36, v112, v4, v36
  v_dot2_f32_bf16 v37, v112, v5, v37
  v_dot2_f32_bf16 v38, v113, v4, v38
  v_dot2_f32_bf16 v39, v113, v5, v39
  v_dot2_f32_bf16 v40, v114, v4, v40
  v_dot2_f32_bf16 v41, v114, v5, v41
  v_dot2_f32_bf16 v42, v115, v4, v42
  v_dot2_f32_bf16 v43, v115, v5, v43
  buffer_load_dwordx4 v[112:115], v19, s[68:71], s85 offen offset:2560 nt
  s_waitcnt vmcnt(19)
  v_dot2_f32_bf16 v44, v116, v4, v44
  v_dot2_f32_bf16 v45, v116, v5, v45
  v_dot2_f32_bf16 v46, v117, v4, v46
  v_dot2_f32_bf16 v47, v117, v5, v47
  v_dot2_f32_bf16 v48, v118, v4, v48
  v_dot2_f32_bf16 v49, v118, v5, v49
  v_dot2_f32_bf16 v50, v119, v4, v50
  v_dot2_f32_bf16 v51, v119, v5, v51
  buffer_load_dwordx4 v[116:119], v19, s[68:71], s85 offen offset:3840 nt
  s_waitcnt vmcnt(19)
  v_dot2_f32_bf16 v52, v24, v4, v52
  v_dot2_f32_bf16 v53, v24, v5, v53
  v_dot2_f32_bf16 v54, v25, v4, v54
  v_dot2_f32_bf16 v55, v25, v5, v55
  v_dot2_f32_bf16 v56, v26, v4, v56
  v_dot2_f32_bf16 v57, v26, v5, v57
  v_dot2_f32_bf16 v58, v27, v4, v58
  v_dot2_f32_bf16 v59, v27, v5, v59
  buffer_load_dwordx4 v[24:27], v19, s[68:71], s86 offen offset:0 nt
  v_cvt_pk_bf16_f32 v4, v14, 0
  v_cvt_pk_bf16_f32 v5, 0, v14
  s_waitcnt vmcnt(19)
  v_dot2_f32_bf16 v36, v28, v4, v36
  v_dot2_f32_bf16 v37, v28, v5, v37
  v_dot2_f32_bf16 v38, v29, v4, v38
  v_dot2_f32_bf16 v39, v29, v5, v39
  v_dot2_f32_bf16 v40, v30, v4, v40
  v_dot2_f32_bf16 v41, v30, v5, v41
  v_dot2_f32_bf16 v42, v31, v4, v42
  v_dot2_f32_bf16 v43, v31, v5, v43
  buffer_load_dwordx4 v[28:31], v19, s[68:71], s86 offen offset:1280 nt
  s_waitcnt vmcnt(19)
  v_dot2_f32_bf16 v44, v32, v4, v44
  v_dot2_f32_bf16 v45, v32, v5, v45
  v_dot2_f32_bf16 v46, v33, v4, v46
  v_dot2_f32_bf16 v47, v33, v5, v47
  v_dot2_f32_bf16 v48, v34, v4, v48
  v_dot2_f32_bf16 v49, v34, v5, v49
  v_dot2_f32_bf16 v50, v35, v4, v50
  v_dot2_f32_bf16 v51, v35, v5, v51
  buffer_load_dwordx4 v[32:35], v19, s[68:71], s86 offen offset:2560 nt
  s_waitcnt vmcnt(19)
  v_dot2_f32_bf16 v52, v60, v4, v52
  v_dot2_f32_bf16 v53, v60, v5, v53
  v_dot2_f32_bf16 v54, v61, v4, v54
  v_dot2_f32_bf16 v55, v61, v5, v55
  v_dot2_f32_bf16 v56, v62, v4, v56
  v_dot2_f32_bf16 v57, v62, v5, v57
  v_dot2_f32_bf16 v58, v63, v4, v58
  v_dot2_f32_bf16 v59, v63, v5, v59
  buffer_load_dwordx4 v[60:63], v19, s[68:71], s86 offen offset:3840 nt
  v_cvt_pk_bf16_f32 v4, v15, 0
  v_cvt_pk_bf16_f32 v5, 0, v15
  s_waitcnt vmcnt(19)
  v_dot2_f32_bf16 v36, v64, v4, v36
  v_dot2_f32_bf16 v37, v64, v5, v37
  v_dot2_f32_bf16 v38, v65, v4, v38
  v_dot2_f32_bf16 v39, v65, v5, v39
  v_dot2_f32_bf16 v40, v66, v4, v40
  v_dot2_f32_bf16 v41, v66, v5, v41
  v_dot2_f32_bf16 v42, v67, v4, v42
  v_dot2_f32_bf16 v43, v67, v5, v43
  s_waitcnt vmcnt(18)
  v_dot2_f32_bf16 v44, v68, v4, v44
  v_dot2_f32_bf16 v45, v68, v5, v45
  v_dot2_f32_bf16 v46, v69, v4, v46
  v_dot2_f32_bf16 v47, v69, v5, v47
  v_dot2_f32_bf16 v48, v70, v4, v48
  v_dot2_f32_bf16 v49, v70, v5, v49
  v_dot2_f32_bf16 v50, v71, v4, v50
  v_dot2_f32_bf16 v51, v71, v5, v51
  s_waitcnt vmcnt(17)
  v_dot2_f32_bf16 v52, v72, v4, v52
  v_dot2_f32_bf16 v53, v72, v5, v53
  v_dot2_f32_bf16 v54, v73, v4, v54
  v_dot2_f32_bf16 v55, v73, v5, v55
  v_dot2_f32_bf16 v56, v74, v4, v56
  v_dot2_f32_bf16 v57, v74, v5, v57
  v_dot2_f32_bf16 v58, v75, v4, v58
  v_dot2_f32_bf16 v59, v75, v5, v59
  v_cvt_pk_bf16_f32 v4, v16, 0
  v_cvt_pk_bf16_f32 v5, 0, v16
  s_waitcnt vmcnt(16)
  v_dot2_f32_bf16 v36, v76, v4, v36
  v_dot2_f32_bf16 v37, v76, v5, v37
  v_dot2_f32_bf16 v38, v77, v4, v38
  v_dot2_f32_bf16 v39, v77, v5, v39
  v_dot2_f32_bf16 v40, v78, v4, v40
  v_dot2_f32_bf16 v41, v78, v5, v41
  v_dot2_f32_bf16 v42, v79, v4, v42
  v_dot2_f32_bf16 v43, v79, v5, v43
  s_waitcnt vmcnt(15)
  v_dot2_f32_bf16 v44, v80, v4, v44
  v_dot2_f32_bf16 v45, v80, v5, v45
  v_dot2_f32_bf16 v46, v81, v4, v46
  v_dot2_f32_bf16 v47, v81, v5, v47
  v_dot2_f32_bf16 v48, v82, v4, v48
  v_dot2_f32_bf16 v49, v82, v5, v49
  v_dot2_f32_bf16 v50, v83, v4, v50
  v_dot2_f32_bf16 v51, v83, v5, v51
  s_waitcnt vmcnt(14)
  v_dot2_f32_bf16 v52, v84, v4, v52
  v_dot2_f32_bf16 v53, v84, v5, v53
  v_dot2_f32_bf16 v54, v85, v4, v54
  v_dot2_f32_bf16 v55, v85, v5, v55
  v_dot2_f32_bf16 v56, v86, v4, v56
  v_dot2_f32_bf16 v57, v86, v5, v57
  v_dot2_f32_bf16 v58, v87, v4, v58
  v_dot2_f32_bf16 v59, v87, v5, v59
  v_permlane32_swap_b32 v36, v40
  v_permlane32_swap_b32 v37, v41
  v_permlane32_swap_b32 v38, v42
  v_permlane32_swap_b32 v39, v43
  v_permlane32_swap_b32 v44, v48
  v_permlane32_swap_b32 v45, v49
  v_permlane32_swap_b32 v46, v50
  v_permlane32_swap_b32 v47, v51
  v_permlane32_swap_b32 v52, v56
  v_permlane32_swap_b32 v53, v57
  v_permlane32_swap_b32 v54, v58
  v_permlane32_swap_b32 v55, v59
  v_add_f32 v36, v36, v40
  v_add_f32 v37, v37, v41
  v_add_f32 v38, v38, v42
  v_add_f32 v39, v39, v43
  v_add_f32 v44, v44, v48
  v_add_f32 v45, v45, v49
  v_add_f32 v46, v46, v50
  v_add_f32 v47, v47, v51
  v_add_f32 v52, v52, v56
  v_add_f32 v53, v53, v57
  v_add_f32 v54, v54, v58
  v_add_f32 v55, v55, v59
  v_permlane16_swap_b32 v36, v38
  v_permlane16_swap_b32 v37, v39
  v_permlane16_swap_b32 v44, v46
  v_permlane16_swap_b32 v45, v47
  v_permlane16_swap_b32 v52, v54
  v_permlane16_swap_b32 v53, v55
  v_add_f32 v36, v36, v38
  v_add_f32 v37, v37, v39
  v_add_f32 v44, v44, v46
  v_add_f32 v45, v45, v47
  v_add_f32 v52, v52, v54
  v_add_f32 v53, v53, v55
  v_add_f32_dpp v36, v36, v36 row_ror:8 row_mask:0xf bank_mask:0xf
  v_add_f32_dpp v37, v37, v37 row_ror:8 row_mask:0xf bank_mask:0xf
  v_add_f32_dpp v44, v44, v44 row_ror:8 row_mask:0xf bank_mask:0xf
  v_add_f32_dpp v45, v45, v45 row_ror:8 row_mask:0xf bank_mask:0xf
  v_add_f32_dpp v52, v52, v52 row_ror:8 row_mask:0xf bank_mask:0xf
  v_add_f32_dpp v53, v53, v53 row_ror:8 row_mask:0xf bank_mask:0xf
  ds_write_b64 v22, v[36:37] offset:9216
  ds_write_b64 v22, v[44:45] offset:9472
  ds_write_b64 v22, v[52:53] offset:9728
  s_waitcnt lgkmcnt(0)
  v_cvt_pk_bf16_f32 v4, v17, 0
  v_cvt_pk_bf16_f32 v5, 0, v17
  s_waitcnt vmcnt(13)
  v_dot2_f32_bf16 v36, v88, v4, 0
  v_dot2_f32_bf16 v37, v88, v5, 0
  v_dot2_f32_bf16 v38, v89, v4, 0
  v_dot2_f32_bf16 v39, v89, v5, 0
  v_dot2_f32_bf16 v40, v90, v4, 0
  v_dot2_f32_bf16 v41, v90, v5, 0
  v_dot2_f32_bf16 v42, v91, v4, 0
  v_dot2_f32_bf16 v43, v91, v5, 0
  s_waitcnt vmcnt(12)
  v_dot2_f32_bf16 v44, v92, v4, 0
  v_dot2_f32_bf16 v45, v92, v5, 0
  v_dot2_f32_bf16 v46, v93, v4, 0
  v_dot2_f32_bf16 v47, v93, v5, 0
  v_dot2_f32_bf16 v48, v94, v4, 0
  v_dot2_f32_bf16 v49, v94, v5, 0
  v_dot2_f32_bf16 v50, v95, v4, 0
  v_dot2_f32_bf16 v51, v95, v5, 0
  s_waitcnt vmcnt(11)
  v_dot2_f32_bf16 v52, v96, v4, 0
  v_dot2_f32_bf16 v53, v96, v5, 0
  v_dot2_f32_bf16 v54, v97, v4, 0
  v_dot2_f32_bf16 v55, v97, v5, 0
  v_dot2_f32_bf16 v56, v98, v4, 0
  v_dot2_f32_bf16 v57, v98, v5, 0
  v_dot2_f32_bf16 v58, v99, v4, 0
  v_dot2_f32_bf16 v59, v99, v5, 0
  v_cvt_pk_bf16_f32 v4, v18, 0
  v_cvt_pk_bf16_f32 v5, 0, v18
  s_waitcnt vmcnt(10)
  v_dot2_f32_bf16 v36, v100, v4, v36
  v_dot2_f32_bf16 v37, v100, v5, v37
  v_dot2_f32_bf16 v38, v101, v4, v38
  v_dot2_f32_bf16 v39, v101, v5, v39
  v_dot2_f32_bf16 v40, v102, v4, v40
  v_dot2_f32_bf16 v41, v102, v5, v41
  v_dot2_f32_bf16 v42, v103, v4, v42
  v_dot2_f32_bf16 v43, v103, v5, v43
  s_waitcnt vmcnt(9)
  v_dot2_f32_bf16 v44, v120, v4, v44
  v_dot2_f32_bf16 v45, v120, v5, v45
  v_dot2_f32_bf16 v46, v121, v4, v46
  v_dot2_f32_bf16 v47, v121, v5, v47
  v_dot2_f32_bf16 v48, v122, v4, v48
  v_dot2_f32_bf16 v49, v122, v5, v49
  v_dot2_f32_bf16 v50, v123, v4, v50
  v_dot2_f32_bf16 v51, v123, v5, v51
  s_waitcnt vmcnt(8)
  v_dot2_f32_bf16 v52, v124, v4, v52
  v_dot2_f32_bf16 v53, v124, v5, v53
  v_dot2_f32_bf16 v54, v125, v4, v54
  v_dot2_f32_bf16 v55, v125, v5, v55
  v_dot2_f32_bf16 v56, v126, v4, v56
  v_dot2_f32_bf16 v57, v126, v5, v57
  v_dot2_f32_bf16 v58, v127, v4, v58
  v_dot2_f32_bf16 v59, v127, v5, v59
  v_permlane32_swap_b32 v36, v40
  v_permlane32_swap_b32 v37, v41
  v_permlane32_swap_b32 v38, v42
  v_permlane32_swap_b32 v39, v43
  v_permlane32_swap_b32 v44, v48
  v_permlane32_swap_b32 v45, v49
  v_permlane32_swap_b32 v46, v50
  v_permlane32_swap_b32 v47, v51
  v_permlane32_swap_b32 v52, v56
  v_permlane32_swap_b32 v53, v57
  v_permlane32_swap_b32 v54, v58
  v_permlane32_swap_b32 v55, v59
  v_add_f32 v36, v36, v40
  v_add_f32 v37, v37, v41
  v_add_f32 v38, v38, v42
  v_add_f32 v39, v39, v43
  v_add_f32 v44, v44, v48
  v_add_f32 v45, v45, v49
  v_add_f32 v46, v46, v50
  v_add_f32 v47, v47, v51
  v_add_f32 v52, v52, v56
  v_add_f32 v53, v53, v57
  v_add_f32 v54, v54, v58
  v_add_f32 v55, v55, v59
  v_permlane16_swap_b32 v36, v38
  v_permlane16_swap_b32 v37, v39
  v_permlane16_swap_b32 v44, v46
  v_permlane16_swap_b32 v45, v47
  v_permlane16_swap_b32 v52, v54
  v_permlane16_swap_b32 v53, v55
  v_add_f32 v36, v36, v38
  v_add_f32 v37, v37, v39
  v_add_f32 v44, v44, v46
  v_add_f32 v45, v45, v47
  v_add_f32 v52, v52, v54
  v_add_f32 v53, v53, v55
  v_add_f32_dpp v36, v36, v36 row_ror:8 row_mask:0xf bank_mask:0xf
  v_add_f32_dpp v37, v37, v37 row_ror:8 row_mask:0xf bank_mask:0xf
  v_add_f32_dpp v44, v44, v44 row_ror:8 row_mask:0xf bank_mask:0xf
  v_add_f32_dpp v45, v45, v45 row_ror:8 row_mask:0xf bank_mask:0xf
  v_add_f32_dpp v52, v52, v52 row_ror:8 row_mask:0xf bank_mask:0xf
  v_add_f32_dpp v53, v53, v53 row_ror:8 row_mask:0xf bank_mask:0xf
  ds_write_b64 v22, v[36:37] offset:21504
  ds_write_b64 v22, v[44:45] offset:21760
  ds_write_b64 v22, v[52:53] offset:22016
  s_cmp_ge_u32 s10, 12
  s_cbranch_scc1 L_late
  s_mov_b32 s11, 0x05040100
  s_mov_b32 s12, 0x07060302
  s_waitcnt vmcnt(0)
  v_perm_b32 v64, v108, v104, s11
  v_perm_b32 v65, v116, v112, s11
  v_perm_b32 v66, v28, v24, s11
  v_perm_b32 v67, v60, v32, s11
  v_perm_b32 v68, v108, v104, s12
  v_perm_b32 v69, v116, v112, s12
  v_perm_b32 v70, v28, v24, s12
  v_perm_b32 v71, v60, v32, s12
  v_perm_b32 v72, v109, v105, s11
  v_perm_b32 v73, v117, v113, s11
  v_perm_b32 v74, v29, v25, s11
  v_perm_b32 v75, v61, v33, s11
  v_perm_b32 v76, v109, v105, s12
  v_perm_b32 v77, v117, v113, s12
  v_perm_b32 v78, v29, v25, s12
  v_perm_b32 v79, v61, v33, s12
  v_perm_b32 v80, v110, v106, s11
  v_perm_b32 v81, v118, v114, s11
  v_perm_b32 v82, v30, v26, s11
  v_perm_b32 v83, v62, v34, s11
  v_perm_b32 v84, v110, v106, s12
  v_perm_b32 v85, v118, v114, s12
  v_perm_b32 v86, v30, v26, s12
  v_perm_b32 v87, v62, v34, s12
  v_perm_b32 v88, v111, v107, s11
  v_perm_b32 v89, v119, v115, s11
  v_perm_b32 v90, v31, v27, s11
  v_perm_b32 v91, v63, v35, s11
  v_perm_b32 v92, v111, v107, s12
  v_perm_b32 v93, v119, v115, s12
  v_perm_b32 v94, v31, v27, s12
  v_perm_b32 v95, v63, v35, s12
  v_and_b32 v100, 1, v1
  v_mul_u32_u24 v100, 384, v100
  v_lshrrev_b32 v101, 4, v1
  v_lshl_add_u32 v100, v101, 4, v100
  s_lshl_b32 s11, s93, 6
  v_add_u32 v100, s11, v100
  v_lshlrev_b32 v101, 5, v1
  s_lshl_b32 s11, s10, 10
  s_add_u32 s11, s11, 34816
  v_add_u32 v101, s11, v101
  v_lshrrev_b32 v102, 8, v0
  v_mul_u32_u24 v102, 5120, v102
  v_lshl_add_u32 v102, v0, 2, v102
  v_lshlrev_b32 v103, 3, v0
  s_cmp_ge_u32 s10, 3
  s_cselect_b32 s11, 1, 0
  s_mul_i32 s12, s11, 3
  s_sub_u32 s12, s10, s12
  v_and_b32 v120, 15, v1
  v_lshlrev_b32 v120, 3, v120
  s_lshl_b32 s13, s11, 7
  v_add_u32 v120, s13, v120
  s_lshl_b32 s13, s12, 6
  v_add_u32 v121, s13, v1
  v_lshlrev_b32 v122, 2, v121
  s_mul_i32 s13, s11, 12288
  v_add_u32 v122, s13, v122
  s_lshl_b32 s13, s3, 1
  s_add_u32 s13, s13, s11
  s_lshl_b32 s13, s13, 3
  s_add_u32 s13, s13, s4
  s_lshl_b32 s13, s13, 11
  s_add_u32 s13, s13, 131072
  v_lshlrev_b32 v121, 3, v121
  v_mov_b32 v123, 1536
  s_mov_b32 s14, 0x3FB8AA3B
  v_mov_b32 v29, s9
  v_mov_b32 v31, s9
  v_mov_b32 v33, s9
  s_waitcnt lgkmcnt(0)
  s_barrier
  s_cmp_ge_u32 s10, 6
  s_cbranch_scc1 L_b4
  ds_read_b64 v[24:25], v120 offset:33792
  ds_read_b32 v104, v122 offset:9216
  ds_read_b32 v105, v122 offset:9984
  ds_read_b32 v106, v122 offset:10752
  ds_read_b32 v107, v122 offset:11520
  ds_read_b32 v108, v122 offset:12288
  ds_read_b32 v109, v122 offset:13056
  ds_read_b32 v110, v122 offset:13824
  ds_read_b32 v111, v122 offset:14592
  ds_read_b32 v112, v122 offset:15360
  ds_read_b32 v113, v122 offset:16128
  ds_read_b32 v114, v122 offset:16896
  ds_read_b32 v115, v122 offset:17664
  ds_read_b32 v116, v122 offset:18432
  ds_read_b32 v117, v122 offset:19200
  ds_read_b32 v118, v122 offset:19968
  ds_read_b32 v119, v122 offset:20736
  s_waitcnt lgkmcnt(14)
  v_max_f32_dpp v28, v24, v24 quad_perm:[1,0,3,2] row_mask:0xf bank_mask:0xf
  s_nop 1
  v_max_f32_dpp v28, v28, v28 quad_perm:[2,3,0,1] row_mask:0xf bank_mask:0xf
  s_nop 1
  v_max_f32_dpp v28, v28, v28 row_half_mirror row_mask:0xf bank_mask:0xf
  s_nop 1
  v_max_f32_dpp v28, v28, v28 row_mirror row_mask:0xf bank_mask:0xf
  v_sub_f32 v24, v24, v28
  v_mul_f32 v24, s14, v24
  v_exp_f32 v24, v24
  s_nop 0
  v_mul_f32 v30, v24, v25
  v_readlane_b32 s16, v24, 0
  v_readlane_b32 s17, v24, 1
  v_add_f32_dpp v30, v30, v30 quad_perm:[1,0,3,2] row_mask:0xf bank_mask:0xf
  v_readlane_b32 s18, v24, 2
  v_readlane_b32 s19, v24, 3
  v_readlane_b32 s20, v24, 4
  v_readlane_b32 s21, v24, 5
  v_add_f32_dpp v30, v30, v30 quad_perm:[2,3,0,1] row_mask:0xf bank_mask:0xf
  v_readlane_b32 s22, v24, 6
  v_readlane_b32 s23, v24, 7
  v_readlane_b32 s24, v24, 8
  v_readlane_b32 s25, v24, 9
  v_add_f32_dpp v30, v30, v30 row_half_mirror row_mask:0xf bank_mask:0xf
  v_readlane_b32 s26, v24, 10
  v_readlane_b32 s27, v24, 11
  v_readlane_b32 s28, v24, 12
  v_readlane_b32 s29, v24, 13
  v_add_f32_dpp v30, v30, v30 row_mirror row_mask:0xf bank_mask:0xf
  v_readlane_b32 s30, v24, 14
  v_readlane_b32 s31, v24, 15
  s_waitcnt lgkmcnt(0)
  v_mul_f32 v32, s16, v104
  v_mul_f32 v34, s17, v105
  v_fmac_f32 v32, s18, v106
  v_fmac_f32 v34, s19, v107
  v_fmac_f32 v32, s20, v108
  v_fmac_f32 v34, s21, v109
  v_fmac_f32 v32, s22, v110
  v_fmac_f32 v34, s23, v111
  v_fmac_f32 v32, s24, v112
  v_fmac_f32 v34, s25, v113
  v_fmac_f32 v32, s26, v114
  v_fmac_f32 v34, s27, v115
  v_fmac_f32 v32, s28, v116
  v_fmac_f32 v34, s29, v117
  v_fmac_f32 v32, s30, v118
  v_fmac_f32 v34, s31, v119
  v_add_f32 v32, v32, v34
  buffer_store_dwordx2 v[32:33], v121, s[72:75], s13 offen sc1
  s_cmp_lg_u32 s12, 0
  s_cbranch_scc1 L_b4
  s_mov_b64 exec, 1
  buffer_store_dwordx4 v[28:31], v123, s[72:75], s13 offen sc1
  s_mov_b64 exec, -1
  s_branch L_b4
L_late:
  s_waitcnt lgkmcnt(0)
  s_barrier
  s_cmp_eq_u32 s10, 12
  s_cbranch_scc1 L_final
  s_sub_u32 s11, s10, 13
  s_lshl_b32 s11, s11, 6
  v_add_u32 v84, s11, v1
  v_cmp_le_u32 vcc, 96, v84
  s_nop 1
  v_cndmask_b32 v85, 0, 1, vcc
  v_mul_u32_u24 v86, 96, v85
  v_sub_u32 v86, v84, v86
  v_lshlrev_b32 v91, 2, v84
  v_lshlrev_b32 v87, 13, v85
  v_lshl_add_u32 v84, v86, 4, v87
  v_add_u32 v85, 4096, v84
  v_and_b32 v86, 3, v1
  v_lshl_add_u32 v86, v86, 11, v87
  s_lshl_b32 s13, s3, 1
  s_add_u32 s13, s13, s5
  s_lshl_b32 s13, s13, 14
  s_add_u32 s13, s13, 131072
  s_mov_b32 s15, 0
  s_mov_b32 s14, 0x3FB8AA3B
L_gflag_loop:
  buffer_load_dwordx4 v[80:83], v86, s[72:75], s13 offen offset:1536 sc1
  s_add_u32 s15, s15, 1
  s_waitcnt vmcnt(0)
  v_xor_b32 v81, s9, v81
  v_xor_b32 v83, s9, v83
  v_or_b32 v81, v81, v83
  v_cmp_ne_u32 vcc, 0, v81
  s_cbranch_vccz L_gflag_done
  s_cmp_lt_u32 s15, 262144
  s_cbranch_scc1 L_gflag_loop
L_gflag_done:
L_gather_loop:
  buffer_load_dwordx4 v[64:67], v84, s[72:75], s13 offen offset:0 sc1
  buffer_load_dwordx4 v[68:71], v84, s[72:75], s13 offen offset:2048 sc1
  buffer_load_dwordx4 v[72:75], v85, s[72:75], s13 offen offset:0 sc1
  buffer_load_dwordx4 v[76:79], v85, s[72:75], s13 offen offset:2048 sc1
  buffer_load_dwordx4 v[80:83], v86, s[72:75], s13 offen offset:1536 sc1
  s_waitcnt vmcnt(0)
  v_max_f32_dpp v88, v80, v80 quad_perm:[1,0,3,2] row_mask:0xf bank_mask:0xf
  v_xor_b32 v4, s9, v65
  v_xor_b32 v67, s9, v67
  v_max_f32_dpp v88, v88, v88 quad_perm:[2,3,0,1] row_mask:0xf bank_mask:0xf
  v_xor_b32 v69, s9, v69
  v_xor_b32 v71, s9, v71
  v_sub_f32 v80, v80, v88
  v_xor_b32 v73, s9, v73
  v_xor_b32 v75, s9, v75
  v_mul_f32 v80, s14, v80
  v_xor_b32 v77, s9, v77
  v_xor_b32 v79, s9, v79
  v_exp_f32 v80, v80
  v_xor_b32 v81, s9, v81
  v_xor_b32 v83, s9, v83
  v_mul_f32 v88, v80, v82
  v_or3_b32 v4, v4, v67, v69
  v_or3_b32 v4, v4, v71, v73
  v_add_f32_dpp v88, v88, v88 quad_perm:[1,0,3,2] row_mask:0xf bank_mask:0xf
  v_mul_f32_dpp v89, v80, v64 quad_perm:[0,0,0,0] row_mask:0xf bank_mask:0xf
  v_mul_f32_dpp v90, v80, v66 quad_perm:[0,0,0,0] row_mask:0xf bank_mask:0xf
  v_or3_b32 v4, v4, v75, v77
  v_add_f32_dpp v88, v88, v88 quad_perm:[2,3,0,1] row_mask:0xf bank_mask:0xf
  v_fmac_f32_dpp v89, v80, v68 quad_perm:[1,1,1,1] row_mask:0xf bank_mask:0xf
  v_fmac_f32_dpp v90, v80, v70 quad_perm:[1,1,1,1] row_mask:0xf bank_mask:0xf
  v_or3_b32 v4, v4, v79, v81
  v_rcp_f32 v88, v88
  v_fmac_f32_dpp v89, v80, v72 quad_perm:[2,2,2,2] row_mask:0xf bank_mask:0xf
  v_fmac_f32_dpp v90, v80, v74 quad_perm:[2,2,2,2] row_mask:0xf bank_mask:0xf
  v_or_b32 v4, v4, v83
  v_fmac_f32_dpp v89, v80, v76 quad_perm:[3,3,3,3] row_mask:0xf bank_mask:0xf
  v_fmac_f32_dpp v90, v80, v78 quad_perm:[3,3,3,3] row_mask:0xf bank_mask:0xf
  v_cmp_ne_u32 vcc, 0, v4
  v_mul_f32 v89, v89, v88
  v_mul_f32 v90, v90, v88
  v_cvt_pk_bf16_f32 v89, v89, v90
  s_cbranch_vccz L_gather_done
  s_add_u32 s15, s15, 1
  s_cmp_lt_u32 s15, 262144
  s_cbranch_scc1 L_gather_loop
L_gather_done:
  ds_write_b32 v91, v89 offset:34048
L_b4l:
  s_waitcnt lgkmcnt(0)
  s_barrier
  s_endpgm
L_b4:
  s_barrier
  s_cmp_ge_u32 s10, s91
  s_cbranch_scc1 L_done
  ds_read_b128 v[96:99], v100 offset:34048
  s_waitcnt lgkmcnt(0)
  v_mfma_f32_16x16x32_bf16 v[104:107], v[96:99], v[64:67], 0
  v_mfma_f32_16x16x32_bf16 v[108:111], v[96:99], v[68:71], 0
  v_mfma_f32_16x16x32_bf16 v[112:115], v[96:99], v[72:75], 0
  v_mfma_f32_16x16x32_bf16 v[116:119], v[96:99], v[76:79], 0
  v_mfma_f32_16x16x32_bf16 v[24:27], v[96:99], v[80:83], 0
  v_mfma_f32_16x16x32_bf16 v[28:31], v[96:99], v[84:87], 0
  v_mfma_f32_16x16x32_bf16 v[32:35], v[96:99], v[88:91], 0
  v_mfma_f32_16x16x32_bf16 v[60:63], v[96:99], v[92:95], 0
  s_mov_b64 exec, 0xffff
  ds_write2_b32 v101, v104, v105 offset0:0 offset1:128
  ds_write2_b32 v101, v108, v109 offset0:1 offset1:129
  ds_write2_b32 v101, v112, v113 offset0:2 offset1:130
  ds_write2_b32 v101, v116, v117 offset0:3 offset1:131
  ds_write2_b32 v101, v24, v25 offset0:4 offset1:132
  ds_write2_b32 v101, v28, v29 offset0:5 offset1:133
  ds_write2_b32 v101, v32, v33 offset0:6 offset1:134
  ds_write2_b32 v101, v60, v61 offset0:7 offset1:135
  s_mov_b64 exec, -1
  v_mov_b32 v97, s9
  s_waitcnt lgkmcnt(0)
  s_barrier
  s_cmp_eq_u32 s6, 3
  s_cselect_b32 s11, 8, 4
  s_cmp_ge_u32 s10, s11
  s_cbranch_scc1 L_done
  ds_read_b32 v64, v102 offset:34816
  ds_read_b32 v65, v102 offset:35840
  ds_read_b32 v66, v102 offset:36864
  ds_read_b32 v67, v102 offset:37888
  ds_read_b32 v68, v102 offset:38912
  ds_read_b32 v69, v102 offset:39936
  s_waitcnt lgkmcnt(4)
  v_add_f32 v64, v64, v65
  s_waitcnt lgkmcnt(2)
  v_add_f32 v66, v66, v67
  s_waitcnt lgkmcnt(0)
  v_add_f32 v68, v68, v69
  v_add_f32 v64, v64, v66
  v_add_f32 v96, v64, v68
  buffer_store_dwordx2 v[96:97], v103, s[72:75], s42 offen sc1
  s_endpgm
L_final:
  s_cmp_ge_u32 s3, 20
  s_cbranch_scc1 L_done
  v_lshrrev_b32 v96, 3, v1
  v_mul_u32_u24 v96, 20480, v96
  v_and_b32 v97, 7, v1
  v_lshl_add_u32 v96, v97, 4, v96
  v_lshlrev_b32 v97, 2, v97
  s_lshl_b32 s13, s3, 3
  s_add_u32 s13, s13, s4
  s_lshl_b32 s11, s13, 7
  s_add_u32 s80, s11, 1179648
  s_add_u32 s81, s80, 163840
  s_add_u32 s82, s81, 163840
  s_add_u32 s83, s82, 163840
  s_mov_b32 s15, 0
  s_lshr_b32 s11, s13, 4
  s_lshl_b32 s11, s11, 7
  s_bfe_u32 s12, s13, 0x10003
  s_mul_i32 s12, s12, 1280
  s_add_u32 s11, s11, s12
  s_and_b32 s12, s13, 7
  s_lshl_b32 s12, s12, 4
  s_add_u32 s11, s11, s12
  s_lshl_b32 s11, s11, 1
  s_barrier
  s_barrier
L_final_loop:
  buffer_load_dwordx4 v[64:67], v96, s[72:75], s80 offen sc1
  buffer_load_dwordx4 v[68:71], v96, s[72:75], s81 offen sc1
  buffer_load_dwordx4 v[72:75], v96, s[72:75], s82 offen sc1
  buffer_load_dwordx4 v[76:79], v96, s[72:75], s83 offen sc1
  s_waitcnt vmcnt(0)
  v_xor_b32 v98, s9, v65
  v_xor_b32 v67, s9, v67
  v_xor_b32 v69, s9, v69
  v_xor_b32 v71, s9, v71
  v_xor_b32 v73, s9, v73
  v_xor_b32 v75, s9, v75
  v_xor_b32 v77, s9, v77
  v_xor_b32 v79, s9, v79
  v_or3_b32 v98, v98, v67, v69
  v_or3_b32 v98, v98, v71, v73
  v_or3_b32 v98, v98, v75, v77
  v_or_b32 v98, v98, v79
  v_cmp_ne_u32 vcc, 0, v98
  s_cbranch_vccz L_final_done0
  s_add_u32 s15, s15, 1
  s_cmp_lt_u32 s15, 262144
  s_cbranch_scc1 L_final_loop
L_final_done0:
  v_add_f32 v100, v64, v68
  v_add_f32 v101, v66, v70
  v_add_f32 v102, v72, v76
  v_add_f32 v103, v74, v78
  v_add_f32 v100, v100, v102
  v_add_f32 v101, v101, v103
L_final_red:
  s_nop 1
  v_add_f32_dpp v100, v100, v100 row_ror:8 row_mask:0xf bank_mask:0xf
  v_add_f32_dpp v101, v101, v101 row_ror:8 row_mask:0xf bank_mask:0xf
  v_mov_b32 v102, v100
  v_mov_b32 v103, v101
  s_nop 0
  v_permlane16_swap_b32 v100, v102
  v_permlane16_swap_b32 v101, v103
  v_add_f32 v100, v100, v102
  v_add_f32 v101, v101, v103
  v_mov_b32 v102, v100
  v_mov_b32 v103, v101
  s_nop 0
  v_permlane32_swap_b32 v100, v102
  v_permlane32_swap_b32 v101, v103
  v_add_f32 v100, v100, v102
  v_add_f32 v101, v101, v103
  v_cvt_pk_bf16_f32 v100, v100, v101
  s_mov_b64 exec, 0xff
  buffer_store_dword v100, v97, s[76:79], s11 offen
  s_mov_b64 exec, 1
  s_or_b32 s11, s3, s4
  s_cmp_lg_u32 s11, 0
  s_cbranch_scc1 L_noepoch
  v_mov_b32 v96, 0
  v_mov_b32 v98, s9
  buffer_store_dword v98, v96, s[72:75], 0 offen
L_noepoch:
  s_nop 7
  s_nop 3
L_done:
  s_endpgm
.section .rodata,"a"
.p2align 6
.amdhsa_kernel concat_heads__mha_block_cached__sliding_block_cached__decode_kernel
  .amdhsa_next_free_vgpr 128
  .amdhsa_next_free_sgpr 102
  .amdhsa_accum_offset 128
  .amdhsa_group_segment_fixed_size 0
  .amdhsa_kernarg_size 104
  .amdhsa_user_sgpr_count 2
  .amdhsa_user_sgpr_kernarg_segment_ptr 1
  .amdhsa_system_sgpr_workgroup_id_x 1
.end_amdhsa_kernel
```
